```python
import torch

def _softmax(x, axis=-1):
    return torch.softmax(x, dim=axis)
def _gelu(x):
    return torch.nn.functional.gelu(x, approximate="tanh")
def _silu(x):
    return torch.nn.functional.silu(x)
def _sigmoid(x):
    return torch.sigmoid(x)
def _layernorm(x, axis=-1, eps=1e-5):
    m = x.mean(dim=axis, keepdim=True)
    v = x.var(dim=axis, keepdim=True, unbiased=False)
    return (x - m) / torch.sqrt(v + eps)
def _scatter_add(tgt, idx, src, axis=0):
    return tgt.clone().index_add_(axis, idx, src)
def _segment_sum(src, seg, n):
    out = torch.zeros((n,) + src.shape[1:], dtype=src.dtype)
    return out.index_add_(0, seg, src)
def _pad(x, pw):
    flat = tuple(v for pair in reversed(pw) for v in pair)
    return torch.nn.functional.pad(x, flat)

kernel_name = 'recurrent_scan__grouped_kv_mqa__glu_gated_reglu__prompt'

def setup_inputs():

    _w = (lambda a: (lambda t: t.to(torch.bfloat16) if t.is_floating_point() else t)(torch.as_tensor(a)))
    def _A_setup():
        B, S, D, H = 1, 2048, 448, 16
        Dh = D // H
        return {
            "x": _w((lambda *s: torch.randn(*s, dtype=torch.bfloat16) * 0.05)(B, S, D)),
            "wq": _w((lambda *s: torch.randn(*s, dtype=torch.bfloat16) * 0.2)(D, H * Dh)),
            "wk": _w((lambda *s: torch.randn(*s, dtype=torch.bfloat16) * 0.2)(D, Dh)),
            "wv": _w((lambda *s: torch.randn(*s, dtype=torch.bfloat16) * 0.2)(D, Dh)),
            "wo": _w((lambda *s: torch.randn(*s, dtype=torch.bfloat16) * 0.2)(H * Dh, D)),
        }
    _A_in = _A_setup()

    def _B_setup():
        B, S, D, F = 1, 2048, 448, 1792
        return {
            "x": _w((lambda *s: torch.randn(*s, dtype=torch.bfloat16) * 0.05)(B, S, D)),
            "W_gate": _w((lambda *s: torch.randn(*s, dtype=torch.bfloat16) * 0.1)(D, F) * (2.0 / D) ** 0.5),
            "W_up": _w((lambda *s: torch.randn(*s, dtype=torch.bfloat16) * 0.1)(D, F) * (2.0 / D) ** 0.5),
            "W_down": _w((lambda *s: torch.randn(*s, dtype=torch.bfloat16) * 0.1)(F, D) * (1.0 / F) ** 0.5),
        }
    _B_in = _B_setup()

    return {
        "A_x": _A_in["x"],
        "A_wq": _A_in["wq"],
        "A_wk": _A_in["wk"],
        "A_wv": _A_in["wv"],
        "A_wo": _A_in["wo"],
        "B_x": _B_in["x"],
        "B_W_gate": _B_in["W_gate"],
        "B_W_up": _B_in["W_up"],
        "B_W_down": _B_in["W_down"],
    }

def reference(A_x, A_wq, A_wk, A_wv, A_wo, B_x, B_W_gate, B_W_up, B_W_down):
    def _A_ref(x, wq, wk, wv, wo):
        B, S, D = x.shape
        H = 16
        Dh = D // H
        q = (lambda x, *d: x.permute(*d))((x @ wq).reshape(B, S, H, Dh), 0, 2, 1, 3)
        k = x @ wk
        v = x @ wv
        scores = torch.einsum("bhqd,bkd->bhqk", q, k) * (Dh ** -0.5)
        p = _softmax(scores, axis=-1)
        o = torch.einsum("bhqk,bkd->bhqd", p, v)
        return (lambda x, *d: x.permute(*d))(o, 0, 2, 1, 3).reshape(B, S, H * Dh) @ wo

    def _B_ref(x, W_gate, W_up, W_down):
        gate = torch.einsum("bsd,df->bsf", x, W_gate)
        up = torch.einsum("bsd,df->bsf", x, W_up)
        gate = gate * (lambda x, dt: x.to(dt))(gate > 0, gate.dtype)
        h = gate * up
        return torch.einsum("bsf,fd->bsd", h, W_down)

    x = A_x
    xn = _layernorm(x, axis=-1)
    s = _A_ref(xn, A_wq, A_wk, A_wv, A_wo)
    g = _silu(_B_ref(xn, B_W_gate, B_W_up, B_W_down))
    return x + s * g
```

```asm
; @launch grid=(256,1,1) block=(512,1,1) lds=151808
.amdgcn_target "amdgcn-amd-amdhsa--gfx950"
.text
.globl recurrent_scan__grouped_kv_mqa__glu_gated_reglu__prompt_kernel
.p2align 8
.type recurrent_scan__grouped_kv_mqa__glu_gated_reglu__prompt_kernel,@function
recurrent_scan__grouped_kv_mqa__glu_gated_reglu__prompt_kernel:
    s_cmp_ge_u32 s2, 256
    s_cbranch_scc1 L_EXIT
    s_getpc_b64 s[4:5]
    s_lshr_b32 s3, s2, 3
    s_min_u32 s3, s3, 24
    s_lshl_b32 s3, s3, 10
    v_lshlrev_b32 v2, 1, v0
    v_add_u32 v2, s3, v2
    global_load_ushort v246, v2, s[4:5]
    s_load_dwordx16 s[8:23], s[0:1], 0
    s_load_dwordx8 s[24:31], s[0:1], 64
    s_memrealtime s[4:5]
    v_and_b32 v1, 63, v0
    v_lshrrev_b32 v2, 6, v0
    s_and_b32 s58, s2, 7
    s_lshr_b32 s59, s2, 3
    v_readfirstlane_b32 s56, v2
    s_and_b32 s66, s58, 1
    s_lshl_b32 s66, s66, 3
    s_and_b32 s62, s59, 7
    s_add_u32 s66, s66, s62
    s_lshr_b32 s60, s58, 1
    s_lshr_b32 s62, s59, 3
    s_mul_i32 s67, s60, 3
    s_add_u32 s67, s67, s62
    s_add_u32 s67, s67, 3
    s_cmp_eq_u32 s62, 0
    s_cselect_b32 s67, s60, s67
    s_and_b32 s68, s56, 3
    s_lshr_b32 s69, s56, 2
    s_and_b32 s99, s59, 7
    s_lshr_b32 s60, s59, 3
    s_lshl_b32 s60, s60, 1
    s_add_u32 s99, s99, s60
    s_sub_u32 s60, s99, 7
    s_cmp_ge_u32 s99, 7
    s_cselect_b32 s99, s60, s99
    s_mov_b32 s98, s99
    s_mov_b32 s100, 0xffff0000
    s_mov_b32 s101, 0x3f803f80
    v_and_b32 v3, 7, v1
    v_lshrrev_b32 v4, 3, v1
    v_lshlrev_b32 v5, 2, v4
    s_lshl_b32 s60, s99, 6
    s_add_u32 s60, s60, s68
    v_add_u32 v5, s60, v5
    v_lshlrev_b32 v6, 4, v3
    v_mul_u32_u24 v7, 896, v4
    v_lshrrev_b32 v8, 4, v1
    v_xor_b32 v8, v3, v8
    v_lshl_add_u32 v56, v8, 4, v7
    v_xor_b32 v8, 4, v8
    v_lshl_add_u32 v57, v8, 4, v7
    v_add_u32 v57, 7168, v57
    s_mul_i32 s6, s68, 1088
    s_mul_i32 s60, s69, 4384
    s_add_u32 s6, s6, s60
    s_lshl_b32 s7, s68, 12
    s_lshl_b32 s60, s69, 11
    s_add_u32 s7, s7, s60
    s_add_u32 s7, s7, 17408
    s_lshl_b32 s60, s66, 7
    s_lshl_b32 s61, s68, 5
    s_add_u32 s60, s60, s61
    s_lshl_b32 s61, s69, 4
    s_add_u32 s60, s60, s61
    s_mul_i32 s3, s60, 896
    v_mul_u32_u24 v10, 3584, v5
    v_add_u32 v10, v10, v6
    v_mov_b32 v11, 0
    v_mov_b32 v54, 114688
    v_mov_b32 v55, 0
    v_mov_b32 v242, 4293476352
    v_mov_b32 v243, -1
    v_mov_b32 v240, 4293476352
    v_mov_b32 v241, -1
    s_waitcnt lgkmcnt(0)
    s_mov_b32 s32, s8
    s_mov_b32 s33, s9
    s_mov_b32 s34, 1835008
    s_mov_b32 s35, 0x00020000
    s_cmp_eq_u32 s69, 0
    s_cselect_b32 s62, s20, s22
    s_cselect_b32 s63, s21, s23
    s_add_u32 s60, s67, 12
    s_lshl_b32 s60, s60, 7
    s_add_u32 s64, s62, s60
    s_addc_u32 s65, s63, 0
    v_lshl_add_u64 v[50:51], s[64:65], 0, v[10:11]
    s_cmp_lt_u32 s67, 4
    s_cbranch_scc1 L_QKV_SETUP
    s_sub_u32 s60, s67, 4
    s_lshl_b32 s60, s60, 7
    s_add_u32 s64, s62, s60
    s_addc_u32 s65, s63, 0
    v_lshl_add_u64 v[48:49], s[64:65], 0, v[10:11]
    v_mov_b32 v52, 114688
    v_mov_b32 v53, 0
    s_branch L_SETUP_DONE
L_QKV_SETUP:
    s_lshl_b32 s60, s67, 1
    s_add_u32 s60, s60, s69
    s_mul_i32 s61, s60, 112
    s_add_u32 s64, s10, s61
    s_addc_u32 s65, s11, 0
    v_mov_b32 v8, s64
    v_mov_b32 v9, s65
    v_mov_b32 v12, 896
    s_cmp_lt_u32 s67, 2
    s_cselect_b32 s62, s12, s14
    s_cselect_b32 s63, s13, s15
    s_and_b32 s60, s60, 3
    s_lshl_b32 s60, s60, 4
    s_min_u32 s60, s60, 40
    v_cmp_eq_u32 vcc, 7, v3
    s_and_saveexec_b64 s[64:65], vcc
    v_mov_b32 v8, s62
    v_mov_b32 v9, s63
    v_mov_b32 v12, 56
    v_mov_b32 v6, s60
    s_mov_b64 exec, s[64:65]
    v_mul_lo_u32 v10, v5, v12
    v_add_u32 v10, v10, v6
    v_lshl_add_u64 v[48:49], v[8:9], 0, v[10:11]
    v_lshlrev_b32 v52, 5, v12
    v_mov_b32 v53, 0
    v_mul_u32_u24 v240, 416, v12
    v_sub_u32 v240, 0, v240
L_SETUP_DONE:
    s_lshl_b32 s62, s98, 7
    s_add_u32 m0, s7, 0
    s_add_u32 s62, s62, s3
    buffer_load_dwordx4 v56, s[32:35], s62 offen lds
    s_add_u32 m0, s6, 0
    s_nop 0
    global_load_lds_dwordx4 v[48:49], off
    v_lshl_add_u64 v[48:49], v[48:49], 0, v[52:53]
    s_lshl_b32 s62, s98, 7
    s_add_u32 m0, s7, 1024
    s_add_u32 s62, s62, s3
    buffer_load_dwordx4 v57, s[32:35], s62 offen lds
    s_add_u32 m0, s6, 8704
    s_nop 0
    global_load_lds_dwordx4 v[48:49], off
    s_add_u32 s98, s98, 1
    s_cmp_eq_u32 s98, 7
    s_cbranch_scc1 WR_3
    v_lshl_add_u64 v[48:49], v[48:49], 0, v[52:53]
    s_branch WD_4
WR_3:
    v_lshl_add_u64 v[48:49], v[48:49], 0, v[240:241]
    s_mov_b32 s98, 0
WD_4:
    s_lshl_b32 s62, s98, 7
    s_add_u32 m0, s7, 33792
    s_add_u32 s62, s62, s3
    buffer_load_dwordx4 v56, s[32:35], s62 offen lds
    s_add_u32 m0, s6, 33792
    s_nop 0
    global_load_lds_dwordx4 v[48:49], off
    v_lshl_add_u64 v[48:49], v[48:49], 0, v[52:53]
    s_lshl_b32 s62, s98, 7
    s_add_u32 m0, s7, 34816
    s_add_u32 s62, s62, s3
    buffer_load_dwordx4 v57, s[32:35], s62 offen lds
    s_add_u32 m0, s6, 42496
    s_nop 0
    global_load_lds_dwordx4 v[48:49], off
    s_add_u32 s98, s98, 1
    s_cmp_eq_u32 s98, 7
    s_cbranch_scc1 WR_7
    v_lshl_add_u64 v[48:49], v[48:49], 0, v[52:53]
    s_branch WD_8
WR_7:
    v_lshl_add_u64 v[48:49], v[48:49], 0, v[240:241]
    s_mov_b32 s98, 0
WD_8:
    s_mov_b32 s36, s30
    s_mov_b32 s37, s31
    s_mov_b32 s38, 11810816
    s_mov_b32 s39, 0x00020000
    s_mov_b32 s40, s24
    s_mov_b32 s41, s25
    s_mov_b32 s42, 1605632
    s_mov_b32 s43, 0x00020000
    s_mov_b32 s44, s16
    s_mov_b32 s45, s17
    s_mov_b32 s46, 401408
    s_mov_b32 s47, 0x00020000
    s_mov_b32 s48, s26
    s_mov_b32 s49, s27
    s_mov_b32 s50, 1835008
    s_mov_b32 s51, 0x00020000
    s_mov_b32 s52, s28
    s_mov_b32 s53, s29
    s_mov_b32 s54, 256
    s_mov_b32 s55, 0x00020000
    s_cmp_lg_u32 s56, 0
    s_cbranch_scc1 L_NONONCE
    v_mov_b32 v8, 0
    v_lshlrev_b32 v9, 2, v1
    v_add_u32 v9, 151552, v9
    ds_write_b32 v9, v8
    s_cmp_lg_u32 s2, 0
    s_cbranch_scc1 L_NONONCE
    s_mul_i32 s5, s5, 0x9e3779b1
    s_xor_b32 s4, s4, s5
    s_or_b32 s4, s4, 1
    v_mov_b32 v9, s4
    buffer_store_dword v9, v8, s[52:55], 0 offen sc1
L_NONONCE:
    v_bfe_u32 v6, v1, 4, 1
    v_lshrrev_b32 v7, 5, v1
    v_bfe_u32 v8, v1, 2, 2
    v_and_b32 v9, 3, v1
    v_mul_u32_u24 v8, 1088, v8
    v_lshl_add_u32 v8, v7, 8, v8
    v_mul_u32_u24 v12, 4384, v6
    v_lshl_add_u32 v12, v9, 3, v12
    s_lshl_b32 s60, s69, 6
    v_add3_u32 v12, v12, v8, s60
    v_add_u32 v13, 32, v12
    v_mov_b32 v23, 0
    s_cmp_ge_u32 s67, 4
    s_cbranch_scc1 L_TRA_DONE
    v_mov_b32 v23, v12
    v_and_b32 v10, 1, v9
    v_lshlrev_b32 v10, 1, v10
    v_lshl_add_u32 v10, v6, 2, v10
    v_lshrrev_b32 v11, 1, v9
    v_add_u32 v10, v10, v11
    v_min_u32 v11, 6, v10
    s_mul_i32 s60, s69, 4384
    v_add_u32 v8, s60, v8
    v_lshl_add_u32 v12, v11, 3, v8
    v_add_u32 v13, 56, v12
    v_cmp_eq_u32 vcc, 6, v10
    s_and_saveexec_b64 s[64:65], vcc
    v_add_u32 v12, 120, v8
    v_add_u32 v13, 112, v8
    s_mov_b64 exec, s[64:65]
    v_sub_u32 v23, v23, v12
L_TRA_DONE:
    v_and_b32 v9, 31, v1
    v_bfe_u32 v10, v1, 1, 3
    v_lshlrev_b32 v11, 7, v9
    s_lshl_b32 s60, s68, 12
    s_add_u32 s60, s60, 17408
    v_add_u32 v11, s60, v11
    s_lshl_b32 s62, s69, 1
    s_add_u32 s62, s62, s68
    s_add_u32 s60, s62, 0
    s_and_b32 s60, s60, 3
    s_lshr_b32 s61, s60, 1
    s_mul_i32 s61, s61, 8704
    s_and_b32 s63, s60, 1
    s_lshl_b32 s63, s63, 9
    s_add_u32 s61, s61, s63
    v_add_u32 v208, s61, v12
    v_add_u32 v216, s61, v13
    v_add_u32 v212, 67584, v208
    v_add_u32 v220, 67584, v216
    s_lshl_b32 s60, s60, 1
    v_add_u32 v8, s60, v7
    v_xor_b32 v8, v8, v10
    v_lshl_add_u32 v224, v8, 4, v11
    v_add_u32 v228, 67584, v224
    s_add_u32 s60, s62, 1
    s_and_b32 s60, s60, 3
    s_lshr_b32 s61, s60, 1
    s_mul_i32 s61, s61, 8704
    s_and_b32 s63, s60, 1
    s_lshl_b32 s63, s63, 9
    s_add_u32 s61, s61, s63
    v_add_u32 v209, s61, v12
    v_add_u32 v217, s61, v13
    v_add_u32 v213, 67584, v209
    v_add_u32 v221, 67584, v217
    s_lshl_b32 s60, s60, 1
    v_add_u32 v8, s60, v7
    v_xor_b32 v8, v8, v10
    v_lshl_add_u32 v225, v8, 4, v11
    v_add_u32 v229, 67584, v225
    s_add_u32 s60, s62, 2
    s_and_b32 s60, s60, 3
    s_lshr_b32 s61, s60, 1
    s_mul_i32 s61, s61, 8704
    s_and_b32 s63, s60, 1
    s_lshl_b32 s63, s63, 9
    s_add_u32 s61, s61, s63
    v_add_u32 v210, s61, v12
    v_add_u32 v218, s61, v13
    v_add_u32 v214, 67584, v210
    v_add_u32 v222, 67584, v218
    s_lshl_b32 s60, s60, 1
    v_add_u32 v8, s60, v7
    v_xor_b32 v8, v8, v10
    v_lshl_add_u32 v226, v8, 4, v11
    v_add_u32 v230, 67584, v226
    s_add_u32 s60, s62, 3
    s_and_b32 s60, s60, 3
    s_lshr_b32 s61, s60, 1
    s_mul_i32 s61, s61, 8704
    s_and_b32 s63, s60, 1
    s_lshl_b32 s63, s63, 9
    s_add_u32 s61, s61, s63
    v_add_u32 v211, s61, v12
    v_add_u32 v219, s61, v13
    v_add_u32 v215, 67584, v211
    v_add_u32 v223, 67584, v219
    s_lshl_b32 s60, s60, 1
    v_add_u32 v8, s60, v7
    v_xor_b32 v8, v8, v10
    v_lshl_add_u32 v227, v8, 4, v11
    v_add_u32 v231, 67584, v227
    v_mov_b32 v16, 0
    v_mov_b32 v17, 0
    v_mov_b32 v18, 0
    v_mov_b32 v19, 0
    v_mov_b32 v20, 0
    v_mov_b32 v21, 0
    s_lshl_b32 s62, s98, 7
    s_add_u32 m0, s7, 67584
    s_add_u32 s62, s62, s3
    buffer_load_dwordx4 v56, s[32:35], s62 offen lds
    s_add_u32 m0, s6, 67584
    s_nop 0
    global_load_lds_dwordx4 v[48:49], off
    v_lshl_add_u64 v[48:49], v[48:49], 0, v[52:53]
    s_lshl_b32 s62, s98, 7
    s_add_u32 m0, s7, 68608
    s_add_u32 s62, s62, s3
    buffer_load_dwordx4 v57, s[32:35], s62 offen lds
    s_add_u32 m0, s6, 76288
    s_nop 0
    global_load_lds_dwordx4 v[48:49], off
    s_add_u32 s98, s98, 1
    s_cmp_eq_u32 s98, 7
    s_cbranch_scc1 WR_11
    v_lshl_add_u64 v[48:49], v[48:49], 0, v[52:53]
    s_branch WD_12
WR_11:
    v_lshl_add_u64 v[48:49], v[48:49], 0, v[240:241]
    s_mov_b32 s98, 0
WD_12:
    s_waitcnt vmcnt(8)
    s_barrier
    ds_read_b128 v[64:67], v224 offset:0
    ds_read_b64_tr_b16 v[32:33], v208 offset:0
    ds_read_b64_tr_b16 v[34:35], v208 offset:128
    ds_read_b64_tr_b16 v[36:37], v216 offset:0
    ds_read_b64_tr_b16 v[38:39], v216 offset:128
    ds_read_b128 v[68:71], v225 offset:0
    ds_read_b64_tr_b16 v[40:41], v209 offset:0
    ds_read_b64_tr_b16 v[42:43], v209 offset:128
    ds_read_b64_tr_b16 v[44:45], v217 offset:0
    ds_read_b64_tr_b16 v[46:47], v217 offset:128
    s_waitcnt lgkmcnt(5)
    v_mfma_f32_32x32x16_bf16 v[176:191], v[32:35], v[64:67], 0
    ds_read_b128 v[72:75], v226 offset:0
    ds_read_b64_tr_b16 v[232:233], v210 offset:0
    ds_read_b64_tr_b16 v[234:235], v210 offset:128
    ds_read_b64_tr_b16 v[236:237], v218 offset:0
    ds_read_b64_tr_b16 v[238:239], v218 offset:128
    v_lshlrev_b32 v24, 16, v32
    v_and_b32 v25, s100, v32
    v_add_f32 v16, v16, v24
    v_add_f32 v17, v17, v25
    v_mfma_f32_32x32x16_bf16 v[192:207], v[36:39], v[64:67], 0
    v_lshlrev_b32 v26, 16, v33
    v_and_b32 v27, s100, v33
    v_add_f32 v16, v16, v26
    v_add_f32 v17, v17, v27
    s_lshl_b32 s62, s98, 7
    s_add_u32 m0, s7, 101376
    s_add_u32 s62, s62, s3
    buffer_load_dwordx4 v56, s[32:35], s62 offen lds
    s_add_u32 m0, s6, 101376
    s_nop 0
    global_load_lds_dwordx4 v[48:49], off
    v_lshl_add_u64 v[48:49], v[48:49], 0, v[52:53]
    s_waitcnt lgkmcnt(5)
    v_mfma_f32_32x32x16_bf16 v[176:191], v[40:43], v[68:71], v[176:191]
    ds_read_b128 v[76:79], v227 offset:0
    ds_read_b64_tr_b16 v[32:33], v211 offset:0
    ds_read_b64_tr_b16 v[34:35], v211 offset:128
    ds_read_b64_tr_b16 v[36:37], v219 offset:0
    ds_read_b64_tr_b16 v[38:39], v219 offset:128
    v_lshlrev_b32 v24, 16, v44
    v_and_b32 v25, s100, v44
    v_add_f32 v18, v18, v24
    v_add_f32 v19, v19, v25
    v_mfma_f32_32x32x16_bf16 v[192:207], v[44:47], v[68:71], v[192:207]
    v_lshlrev_b32 v26, 16, v45
    v_and_b32 v27, s100, v45
    v_add_f32 v18, v18, v26
    v_add_f32 v19, v19, v27
    s_lshl_b32 s62, s98, 7
    s_add_u32 m0, s7, 102400
    s_add_u32 s62, s62, s3
    buffer_load_dwordx4 v57, s[32:35], s62 offen lds
    s_add_u32 m0, s6, 110080
    s_nop 0
    global_load_lds_dwordx4 v[48:49], off
    s_add_u32 s98, s98, 1
    s_cmp_eq_u32 s98, 7
    s_cbranch_scc1 WR_15
    v_lshl_add_u64 v[48:49], v[48:49], 0, v[52:53]
    s_branch WD_16
WR_15:
    v_lshl_add_u64 v[48:49], v[48:49], 0, v[240:241]
    s_mov_b32 s98, 0
WD_16:
    v_dot2c_f32_bf16 v20, s101, v64
    v_dot2c_f32_bf16 v21, v64, v64
    v_dot2c_f32_bf16 v20, s101, v65
    v_dot2c_f32_bf16 v21, v65, v65
    v_dot2c_f32_bf16 v20, s101, v66
    v_dot2c_f32_bf16 v21, v66, v66
    v_dot2c_f32_bf16 v20, s101, v67
    v_dot2c_f32_bf16 v21, v67, v67
    v_dot2c_f32_bf16 v20, s101, v68
    v_dot2c_f32_bf16 v21, v68, v68
    v_dot2c_f32_bf16 v20, s101, v69
    v_dot2c_f32_bf16 v21, v69, v69
    v_dot2c_f32_bf16 v20, s101, v70
    v_dot2c_f32_bf16 v21, v70, v70
    v_dot2c_f32_bf16 v20, s101, v71
    v_dot2c_f32_bf16 v21, v71, v71
    s_waitcnt lgkmcnt(0)
    s_waitcnt vmcnt(8)
    s_barrier
    v_mfma_f32_32x32x16_bf16 v[176:191], v[232:235], v[72:75], v[176:191]
    ds_read_b128 v[80:83], v224 offset:33792
    ds_read_b64_tr_b16 v[40:41], v208 offset:33792
    ds_read_b64_tr_b16 v[42:43], v208 offset:33920
    ds_read_b64_tr_b16 v[44:45], v216 offset:33792
    ds_read_b64_tr_b16 v[46:47], v216 offset:33920
    v_lshlrev_b32 v24, 16, v234
    v_and_b32 v25, s100, v234
    v_add_f32 v16, v16, v24
    v_add_f32 v17, v17, v25
    v_mfma_f32_32x32x16_bf16 v[192:207], v[236:239], v[72:75], v[192:207]
    v_lshlrev_b32 v26, 16, v235
    v_and_b32 v27, s100, v235
    v_add_f32 v16, v16, v26
    v_add_f32 v17, v17, v27
    s_lshl_b32 s62, s98, 7
    s_add_u32 m0, s7, 0
    s_add_u32 s62, s62, s3
    buffer_load_dwordx4 v56, s[32:35], s62 offen lds
    s_waitcnt lgkmcnt(5)
    v_mfma_f32_32x32x16_bf16 v[176:191], v[32:35], v[76:79], v[176:191]
    ds_read_b128 v[84:87], v225 offset:33792
    ds_read_b64_tr_b16 v[232:233], v209 offset:33792
    ds_read_b64_tr_b16 v[234:235], v209 offset:33920
    ds_read_b64_tr_b16 v[236:237], v217 offset:33792
    ds_read_b64_tr_b16 v[238:239], v217 offset:33920
    v_lshlrev_b32 v24, 16, v38
    v_and_b32 v25, s100, v38
    v_add_f32 v18, v18, v24
    v_add_f32 v19, v19, v25
    v_mfma_f32_32x32x16_bf16 v[192:207], v[36:39], v[76:79], v[192:207]
    v_lshlrev_b32 v26, 16, v39
    v_and_b32 v27, s100, v39
    v_add_f32 v18, v18, v26
    v_add_f32 v19, v19, v27
    s_add_u32 m0, s6, 0
    s_nop 0
    global_load_lds_dwordx4 v[48:49], off
    v_lshl_add_u64 v[48:49], v[48:49], 0, v[52:53]
    s_waitcnt lgkmcnt(5)
    v_mfma_f32_32x32x16_bf16 v[176:191], v[40:43], v[80:83], v[176:191]
    ds_read_b128 v[88:91], v226 offset:33792
    ds_read_b64_tr_b16 v[32:33], v210 offset:33792
    ds_read_b64_tr_b16 v[34:35], v210 offset:33920
    ds_read_b64_tr_b16 v[36:37], v218 offset:33792
    ds_read_b64_tr_b16 v[38:39], v218 offset:33920
    v_lshlrev_b32 v24, 16, v40
    v_and_b32 v25, s100, v40
    v_add_f32 v16, v16, v24
    v_add_f32 v17, v17, v25
    v_mfma_f32_32x32x16_bf16 v[192:207], v[44:47], v[80:83], v[192:207]
    v_lshlrev_b32 v26, 16, v41
    v_and_b32 v27, s100, v41
    v_add_f32 v16, v16, v26
    v_add_f32 v17, v17, v27
    s_lshl_b32 s62, s98, 7
    s_add_u32 m0, s7, 1024
    s_add_u32 s62, s62, s3
    buffer_load_dwordx4 v57, s[32:35], s62 offen lds
    s_waitcnt lgkmcnt(5)
    v_mfma_f32_32x32x16_bf16 v[176:191], v[232:235], v[84:87], v[176:191]
    ds_read_b128 v[92:95], v227 offset:33792
    ds_read_b64_tr_b16 v[40:41], v211 offset:33792
    ds_read_b64_tr_b16 v[42:43], v211 offset:33920
    ds_read_b64_tr_b16 v[44:45], v219 offset:33792
    ds_read_b64_tr_b16 v[46:47], v219 offset:33920
    v_lshlrev_b32 v24, 16, v236
    v_and_b32 v25, s100, v236
    v_add_f32 v18, v18, v24
    v_add_f32 v19, v19, v25
    v_mfma_f32_32x32x16_bf16 v[192:207], v[236:239], v[84:87], v[192:207]
    v_lshlrev_b32 v26, 16, v237
    v_and_b32 v27, s100, v237
    v_add_f32 v18, v18, v26
    v_add_f32 v19, v19, v27
    s_add_u32 m0, s6, 8704
    s_nop 0
    global_load_lds_dwordx4 v[48:49], off
    s_add_u32 s98, s98, 1
    s_cmp_eq_u32 s98, 7
    s_cbranch_scc1 WR_19
    v_lshl_add_u64 v[48:49], v[48:49], 0, v[52:53]
    s_branch WD_20
WR_19:
    v_lshl_add_u64 v[48:49], v[48:49], 0, v[240:241]
    s_mov_b32 s98, 0
WD_20:
    v_dot2c_f32_bf16 v20, s101, v80
    v_dot2c_f32_bf16 v21, v80, v80
    v_dot2c_f32_bf16 v20, s101, v81
    v_dot2c_f32_bf16 v21, v81, v81
    v_dot2c_f32_bf16 v20, s101, v82
    v_dot2c_f32_bf16 v21, v82, v82
    v_dot2c_f32_bf16 v20, s101, v83
    v_dot2c_f32_bf16 v21, v83, v83
    v_dot2c_f32_bf16 v20, s101, v84
    v_dot2c_f32_bf16 v21, v84, v84
    v_dot2c_f32_bf16 v20, s101, v85
    v_dot2c_f32_bf16 v21, v85, v85
    v_dot2c_f32_bf16 v20, s101, v86
    v_dot2c_f32_bf16 v21, v86, v86
    v_dot2c_f32_bf16 v20, s101, v87
    v_dot2c_f32_bf16 v21, v87, v87
    s_waitcnt lgkmcnt(0)
    s_waitcnt vmcnt(8)
    s_barrier
    v_mfma_f32_32x32x16_bf16 v[176:191], v[32:35], v[88:91], v[176:191]
    ds_read_b128 v[96:99], v228 offset:0
    ds_read_b64_tr_b16 v[232:233], v212 offset:0
    ds_read_b64_tr_b16 v[234:235], v212 offset:128
    ds_read_b64_tr_b16 v[236:237], v220 offset:0
    ds_read_b64_tr_b16 v[238:239], v220 offset:128
    v_lshlrev_b32 v24, 16, v34
    v_and_b32 v25, s100, v34
    v_add_f32 v16, v16, v24
    v_add_f32 v17, v17, v25
    v_mfma_f32_32x32x16_bf16 v[192:207], v[36:39], v[88:91], v[192:207]
    v_lshlrev_b32 v26, 16, v35
    v_and_b32 v27, s100, v35
    v_add_f32 v16, v16, v26
    v_add_f32 v17, v17, v27
    s_lshl_b32 s62, s98, 7
    s_add_u32 m0, s7, 33792
    s_add_u32 s62, s62, s3
    buffer_load_dwordx4 v56, s[32:35], s62 offen lds
    s_waitcnt lgkmcnt(5)
    v_mfma_f32_32x32x16_bf16 v[176:191], v[40:43], v[92:95], v[176:191]
    ds_read_b128 v[100:103], v229 offset:0
    ds_read_b64_tr_b16 v[32:33], v213 offset:0
    ds_read_b64_tr_b16 v[34:35], v213 offset:128
    ds_read_b64_tr_b16 v[36:37], v221 offset:0
    ds_read_b64_tr_b16 v[38:39], v221 offset:128
    v_lshlrev_b32 v24, 16, v46
    v_and_b32 v25, s100, v46
    v_add_f32 v18, v18, v24
    v_add_f32 v19, v19, v25
    v_mfma_f32_32x32x16_bf16 v[192:207], v[44:47], v[92:95], v[192:207]
    v_lshlrev_b32 v26, 16, v47
    v_and_b32 v27, s100, v47
    v_add_f32 v18, v18, v26
    v_add_f32 v19, v19, v27
    s_add_u32 m0, s6, 33792
    s_nop 0
    global_load_lds_dwordx4 v[48:49], off
    v_lshl_add_u64 v[48:49], v[48:49], 0, v[52:53]
    s_waitcnt lgkmcnt(5)
    v_mfma_f32_32x32x16_bf16 v[176:191], v[232:235], v[96:99], v[176:191]
    ds_read_b128 v[104:107], v230 offset:0
    ds_read_b64_tr_b16 v[40:41], v214 offset:0
    ds_read_b64_tr_b16 v[42:43], v214 offset:128
    ds_read_b64_tr_b16 v[44:45], v222 offset:0
    ds_read_b64_tr_b16 v[46:47], v222 offset:128
    v_lshlrev_b32 v24, 16, v232
    v_and_b32 v25, s100, v232
    v_add_f32 v16, v16, v24
    v_add_f32 v17, v17, v25
    v_mfma_f32_32x32x16_bf16 v[192:207], v[236:239], v[96:99], v[192:207]
    v_lshlrev_b32 v26, 16, v233
    v_and_b32 v27, s100, v233
    v_add_f32 v16, v16, v26
    v_add_f32 v17, v17, v27
    s_lshl_b32 s62, s98, 7
    s_add_u32 m0, s7, 34816
    s_add_u32 s62, s62, s3
    buffer_load_dwordx4 v57, s[32:35], s62 offen lds
    s_waitcnt lgkmcnt(5)
    v_mfma_f32_32x32x16_bf16 v[176:191], v[32:35], v[100:103], v[176:191]
    ds_read_b128 v[108:111], v231 offset:0
    ds_read_b64_tr_b16 v[232:233], v215 offset:0
    ds_read_b64_tr_b16 v[234:235], v215 offset:128
    ds_read_b64_tr_b16 v[236:237], v223 offset:0
    ds_read_b64_tr_b16 v[238:239], v223 offset:128
    v_lshlrev_b32 v24, 16, v36
    v_and_b32 v25, s100, v36
    v_add_f32 v18, v18, v24
    v_add_f32 v19, v19, v25
    v_mfma_f32_32x32x16_bf16 v[192:207], v[36:39], v[100:103], v[192:207]
    v_lshlrev_b32 v26, 16, v37
    v_and_b32 v27, s100, v37
    v_add_f32 v18, v18, v26
    v_add_f32 v19, v19, v27
    s_add_u32 m0, s6, 42496
    s_nop 0
    global_load_lds_dwordx4 v[48:49], off
    s_add_u32 s98, s98, 1
    s_cmp_eq_u32 s98, 7
    s_cbranch_scc1 WR_23
    v_lshl_add_u64 v[48:49], v[48:49], 0, v[52:53]
    s_branch WD_24
WR_23:
    v_lshl_add_u64 v[48:49], v[48:49], 0, v[240:241]
    s_mov_b32 s98, 0
WD_24:
    v_dot2c_f32_bf16 v20, s101, v96
    v_dot2c_f32_bf16 v21, v96, v96
    v_dot2c_f32_bf16 v20, s101, v97
    v_dot2c_f32_bf16 v21, v97, v97
    v_dot2c_f32_bf16 v20, s101, v98
    v_dot2c_f32_bf16 v21, v98, v98
    v_dot2c_f32_bf16 v20, s101, v99
    v_dot2c_f32_bf16 v21, v99, v99
    v_dot2c_f32_bf16 v20, s101, v100
    v_dot2c_f32_bf16 v21, v100, v100
    v_dot2c_f32_bf16 v20, s101, v101
    v_dot2c_f32_bf16 v21, v101, v101
    v_dot2c_f32_bf16 v20, s101, v102
    v_dot2c_f32_bf16 v21, v102, v102
    v_dot2c_f32_bf16 v20, s101, v103
    v_dot2c_f32_bf16 v21, v103, v103
    s_waitcnt lgkmcnt(0)
    s_waitcnt vmcnt(8)
    s_barrier
    v_mfma_f32_32x32x16_bf16 v[176:191], v[40:43], v[104:107], v[176:191]
    ds_read_b128 v[112:115], v228 offset:33792
    ds_read_b64_tr_b16 v[32:33], v212 offset:33792
    ds_read_b64_tr_b16 v[34:35], v212 offset:33920
    ds_read_b64_tr_b16 v[36:37], v220 offset:33792
    ds_read_b64_tr_b16 v[38:39], v220 offset:33920
    v_lshlrev_b32 v24, 16, v42
    v_and_b32 v25, s100, v42
    v_add_f32 v16, v16, v24
    v_add_f32 v17, v17, v25
    v_mfma_f32_32x32x16_bf16 v[192:207], v[44:47], v[104:107], v[192:207]
    v_lshlrev_b32 v26, 16, v43
    v_and_b32 v27, s100, v43
    v_add_f32 v16, v16, v26
    v_add_f32 v17, v17, v27
    s_lshl_b32 s62, s98, 7
    s_add_u32 m0, s7, 67584
    s_add_u32 s62, s62, s3
    buffer_load_dwordx4 v56, s[32:35], s62 offen lds
    s_waitcnt lgkmcnt(5)
    v_mfma_f32_32x32x16_bf16 v[176:191], v[232:235], v[108:111], v[176:191]
    ds_read_b128 v[116:119], v229 offset:33792
    ds_read_b64_tr_b16 v[40:41], v213 offset:33792
    ds_read_b64_tr_b16 v[42:43], v213 offset:33920
    ds_read_b64_tr_b16 v[44:45], v221 offset:33792
    ds_read_b64_tr_b16 v[46:47], v221 offset:33920
    v_lshlrev_b32 v24, 16, v238
    v_and_b32 v25, s100, v238
    v_add_f32 v18, v18, v24
    v_add_f32 v19, v19, v25
    v_mfma_f32_32x32x16_bf16 v[192:207], v[236:239], v[108:111], v[192:207]
    v_lshlrev_b32 v26, 16, v239
    v_and_b32 v27, s100, v239
    v_add_f32 v18, v18, v26
    v_add_f32 v19, v19, v27
    s_add_u32 m0, s6, 67584
    s_nop 0
    global_load_lds_dwordx4 v[48:49], off
    v_lshl_add_u64 v[48:49], v[48:49], 0, v[52:53]
    s_waitcnt lgkmcnt(5)
    v_mfma_f32_32x32x16_bf16 v[176:191], v[32:35], v[112:115], v[176:191]
    ds_read_b128 v[120:123], v230 offset:33792
    ds_read_b64_tr_b16 v[232:233], v214 offset:33792
    ds_read_b64_tr_b16 v[234:235], v214 offset:33920
    ds_read_b64_tr_b16 v[236:237], v222 offset:33792
    ds_read_b64_tr_b16 v[238:239], v222 offset:33920
    v_lshlrev_b32 v24, 16, v32
    v_and_b32 v25, s100, v32
    v_add_f32 v16, v16, v24
    v_add_f32 v17, v17, v25
    v_mfma_f32_32x32x16_bf16 v[192:207], v[36:39], v[112:115], v[192:207]
    v_lshlrev_b32 v26, 16, v33
    v_and_b32 v27, s100, v33
    v_add_f32 v16, v16, v26
    v_add_f32 v17, v17, v27
    v_mov_b32 v2, 0
    buffer_load_dword v3, v2, s[52:55], 0 offen sc1
    s_lshl_b32 s62, s98, 7
    s_add_u32 m0, s7, 68608
    s_add_u32 s62, s62, s3
    buffer_load_dwordx4 v57, s[32:35], s62 offen lds
    s_waitcnt lgkmcnt(5)
    v_mfma_f32_32x32x16_bf16 v[176:191], v[40:43], v[116:119], v[176:191]
    ds_read_b128 v[124:127], v231 offset:33792
    ds_read_b64_tr_b16 v[32:33], v215 offset:33792
    ds_read_b64_tr_b16 v[34:35], v215 offset:33920
    ds_read_b64_tr_b16 v[36:37], v223 offset:33792
    ds_read_b64_tr_b16 v[38:39], v223 offset:33920
    v_lshlrev_b32 v24, 16, v44
    v_and_b32 v25, s100, v44
    v_add_f32 v18, v18, v24
    v_add_f32 v19, v19, v25
    v_mfma_f32_32x32x16_bf16 v[192:207], v[44:47], v[116:119], v[192:207]
    v_lshlrev_b32 v26, 16, v45
    v_and_b32 v27, s100, v45
    v_add_f32 v18, v18, v26
    v_add_f32 v19, v19, v27
    s_add_u32 m0, s6, 76288
    s_nop 0
    global_load_lds_dwordx4 v[48:49], off
    s_add_u32 s98, s98, 1
    s_cmp_eq_u32 s98, 7
    s_cbranch_scc1 WR_27
    v_lshl_add_u64 v[48:49], v[48:49], 0, v[52:53]
    s_branch WD_28
WR_27:
    v_lshl_add_u64 v[48:49], v[48:49], 0, v[240:241]
    s_mov_b32 s98, 0
WD_28:
    v_dot2c_f32_bf16 v20, s101, v112
    v_dot2c_f32_bf16 v21, v112, v112
    v_dot2c_f32_bf16 v20, s101, v113
    v_dot2c_f32_bf16 v21, v113, v113
    v_dot2c_f32_bf16 v20, s101, v114
    v_dot2c_f32_bf16 v21, v114, v114
    v_dot2c_f32_bf16 v20, s101, v115
    v_dot2c_f32_bf16 v21, v115, v115
    v_dot2c_f32_bf16 v20, s101, v116
    v_dot2c_f32_bf16 v21, v116, v116
    v_dot2c_f32_bf16 v20, s101, v117
    v_dot2c_f32_bf16 v21, v117, v117
    v_dot2c_f32_bf16 v20, s101, v118
    v_dot2c_f32_bf16 v21, v118, v118
    v_dot2c_f32_bf16 v20, s101, v119
    v_dot2c_f32_bf16 v21, v119, v119
    s_waitcnt lgkmcnt(0)
    s_waitcnt vmcnt(9)
    s_barrier
    v_mfma_f32_32x32x16_bf16 v[176:191], v[232:235], v[120:123], v[176:191]
    ds_read_b128 v[128:131], v224 offset:0
    ds_read_b64_tr_b16 v[40:41], v208 offset:0
    ds_read_b64_tr_b16 v[42:43], v208 offset:128
    ds_read_b64_tr_b16 v[44:45], v216 offset:0
    ds_read_b64_tr_b16 v[46:47], v216 offset:128
    v_lshlrev_b32 v24, 16, v234
    v_and_b32 v25, s100, v234
    v_add_f32 v16, v16, v24
    v_add_f32 v17, v17, v25
    v_mfma_f32_32x32x16_bf16 v[192:207], v[236:239], v[120:123], v[192:207]
    v_lshlrev_b32 v26, 16, v235
    v_and_b32 v27, s100, v235
    v_add_f32 v16, v16, v26
    v_add_f32 v17, v17, v27
    s_add_u32 m0, s6, 101376
    s_nop 0
    global_load_lds_dwordx4 v[50:51], off
    v_lshl_add_u64 v[50:51], v[50:51], 0, v[54:55]
    s_waitcnt lgkmcnt(5)
    v_mfma_f32_32x32x16_bf16 v[176:191], v[32:35], v[124:127], v[176:191]
    ds_read_b128 v[132:135], v225 offset:0
    ds_read_b64_tr_b16 v[232:233], v209 offset:0
    ds_read_b64_tr_b16 v[234:235], v209 offset:128
    ds_read_b64_tr_b16 v[236:237], v217 offset:0
    ds_read_b64_tr_b16 v[238:239], v217 offset:128
    v_lshlrev_b32 v24, 16, v38
    v_and_b32 v25, s100, v38
    v_add_f32 v18, v18, v24
    v_add_f32 v19, v19, v25
    v_mfma_f32_32x32x16_bf16 v[192:207], v[36:39], v[124:127], v[192:207]
    v_lshlrev_b32 v26, 16, v39
    v_and_b32 v27, s100, v39
    v_add_f32 v18, v18, v26
    v_add_f32 v19, v19, v27
    s_add_u32 m0, s6, 110080
    s_nop 0
    global_load_lds_dwordx4 v[50:51], off
    s_add_u32 s98, s98, 1
    s_cmp_eq_u32 s98, 7
    s_cbranch_scc1 WR_29
    v_lshl_add_u64 v[50:51], v[50:51], 0, v[54:55]
    s_branch WD_30
WR_29:
    v_lshl_add_u64 v[50:51], v[50:51], 0, v[242:243]
    s_mov_b32 s98, 0
WD_30:
    s_waitcnt lgkmcnt(5)
    v_mfma_f32_32x32x16_bf16 v[176:191], v[40:43], v[128:131], v[176:191]
    ds_read_b128 v[136:139], v226 offset:0
    ds_read_b64_tr_b16 v[32:33], v210 offset:0
    ds_read_b64_tr_b16 v[34:35], v210 offset:128
    ds_read_b64_tr_b16 v[36:37], v218 offset:0
    ds_read_b64_tr_b16 v[38:39], v218 offset:128
    v_lshlrev_b32 v24, 16, v40
    v_and_b32 v25, s100, v40
    v_add_f32 v16, v16, v24
    v_add_f32 v17, v17, v25
    v_mfma_f32_32x32x16_bf16 v[192:207], v[44:47], v[128:131], v[192:207]
    v_lshlrev_b32 v26, 16, v41
    v_and_b32 v27, s100, v41
    v_add_f32 v16, v16, v26
    v_add_f32 v17, v17, v27
    s_waitcnt lgkmcnt(5)
    v_mfma_f32_32x32x16_bf16 v[176:191], v[232:235], v[132:135], v[176:191]
    ds_read_b128 v[140:143], v227 offset:0
    ds_read_b64_tr_b16 v[40:41], v211 offset:0
    ds_read_b64_tr_b16 v[42:43], v211 offset:128
    ds_read_b64_tr_b16 v[44:45], v219 offset:0
    ds_read_b64_tr_b16 v[46:47], v219 offset:128
    v_lshlrev_b32 v24, 16, v236
    v_and_b32 v25, s100, v236
    v_add_f32 v18, v18, v24
    v_add_f32 v19, v19, v25
    v_mfma_f32_32x32x16_bf16 v[192:207], v[236:239], v[132:135], v[192:207]
    v_lshlrev_b32 v26, 16, v237
    v_and_b32 v27, s100, v237
    v_add_f32 v18, v18, v26
    v_add_f32 v19, v19, v27
    v_dot2c_f32_bf16 v20, s101, v128
    v_dot2c_f32_bf16 v21, v128, v128
    v_dot2c_f32_bf16 v20, s101, v129
    v_dot2c_f32_bf16 v21, v129, v129
    v_dot2c_f32_bf16 v20, s101, v130
    v_dot2c_f32_bf16 v21, v130, v130
    v_dot2c_f32_bf16 v20, s101, v131
    v_dot2c_f32_bf16 v21, v131, v131
    v_dot2c_f32_bf16 v20, s101, v132
    v_dot2c_f32_bf16 v21, v132, v132
    v_dot2c_f32_bf16 v20, s101, v133
    v_dot2c_f32_bf16 v21, v133, v133
    v_dot2c_f32_bf16 v20, s101, v134
    v_dot2c_f32_bf16 v21, v134, v134
    v_dot2c_f32_bf16 v20, s101, v135
    v_dot2c_f32_bf16 v21, v135, v135
    s_waitcnt lgkmcnt(0)
    s_waitcnt vmcnt(7)
    s_barrier
    v_mfma_f32_32x32x16_bf16 v[176:191], v[32:35], v[136:139], v[176:191]
    ds_read_b128 v[144:147], v224 offset:33792
    ds_read_b64_tr_b16 v[232:233], v208 offset:33792
    ds_read_b64_tr_b16 v[234:235], v208 offset:33920
    ds_read_b64_tr_b16 v[236:237], v216 offset:33792
    ds_read_b64_tr_b16 v[238:239], v216 offset:33920
    v_lshlrev_b32 v24, 16, v34
    v_and_b32 v25, s100, v34
    v_add_f32 v16, v16, v24
    v_add_f32 v17, v17, v25
    v_mfma_f32_32x32x16_bf16 v[192:207], v[36:39], v[136:139], v[192:207]
    v_lshlrev_b32 v26, 16, v35
    v_and_b32 v27, s100, v35
    v_add_f32 v16, v16, v26
    v_add_f32 v17, v17, v27
    s_add_u32 m0, s6, 0
    s_nop 0
    global_load_lds_dwordx4 v[50:51], off
    v_lshl_add_u64 v[50:51], v[50:51], 0, v[54:55]
    s_waitcnt lgkmcnt(5)
    v_mfma_f32_32x32x16_bf16 v[176:191], v[40:43], v[140:143], v[176:191]
    ds_read_b128 v[148:151], v225 offset:33792
    ds_read_b64_tr_b16 v[32:33], v209 offset:33792
    ds_read_b64_tr_b16 v[34:35], v209 offset:33920
    ds_read_b64_tr_b16 v[36:37], v217 offset:33792
    ds_read_b64_tr_b16 v[38:39], v217 offset:33920
    v_lshlrev_b32 v24, 16, v46
    v_and_b32 v25, s100, v46
    v_add_f32 v18, v18, v24
    v_add_f32 v19, v19, v25
    v_mfma_f32_32x32x16_bf16 v[192:207], v[44:47], v[140:143], v[192:207]
    v_lshlrev_b32 v26, 16, v47
    v_and_b32 v27, s100, v47
    v_add_f32 v18, v18, v26
    v_add_f32 v19, v19, v27
    s_lshl_b32 s60, s66, 2
    s_add_u32 s60, s60, s68
    s_lshl_b32 s60, s60, 4
    s_add_u32 s60, s60, s67
    s_lshl_b32 s60, s60, 1
    s_add_u32 s60, s60, s69
    s_lshl_b32 s60, s60, 10
    s_add_u32 s60, s60, 9707520
    v_lshlrev_b32 v8, 4, v1
    v_mov_b32 v12, 0
    v_mov_b32 v13, 0
    v_mov_b32 v14, 0
    v_mov_b32 v15, 0
    buffer_store_dwordx4 v[12:15], v8, s[36:39], s60 offen sc1
    s_add_u32 m0, s6, 8704
    s_nop 0
    global_load_lds_dwordx4 v[50:51], off
    s_add_u32 s98, s98, 1
    s_cmp_eq_u32 s98, 7
    s_cbranch_scc1 WR_31
    v_lshl_add_u64 v[50:51], v[50:51], 0, v[54:55]
    s_branch WD_32
WR_31:
    v_lshl_add_u64 v[50:51], v[50:51], 0, v[242:243]
    s_mov_b32 s98, 0
WD_32:
    s_waitcnt lgkmcnt(5)
    v_mfma_f32_32x32x16_bf16 v[176:191], v[232:235], v[144:147], v[176:191]
    ds_read_b128 v[152:155], v226 offset:33792
    ds_read_b64_tr_b16 v[40:41], v210 offset:33792
    ds_read_b64_tr_b16 v[42:43], v210 offset:33920
    ds_read_b64_tr_b16 v[44:45], v218 offset:33792
    ds_read_b64_tr_b16 v[46:47], v218 offset:33920
    v_lshlrev_b32 v24, 16, v232
    v_and_b32 v25, s100, v232
    v_add_f32 v16, v16, v24
    v_add_f32 v17, v17, v25
    v_mfma_f32_32x32x16_bf16 v[192:207], v[236:239], v[144:147], v[192:207]
    v_lshlrev_b32 v26, 16, v233
    v_and_b32 v27, s100, v233
    v_add_f32 v16, v16, v26
    v_add_f32 v17, v17, v27
    s_waitcnt lgkmcnt(5)
    v_mfma_f32_32x32x16_bf16 v[176:191], v[32:35], v[148:151], v[176:191]
    ds_read_b128 v[156:159], v227 offset:33792
    ds_read_b64_tr_b16 v[232:233], v211 offset:33792
    ds_read_b64_tr_b16 v[234:235], v211 offset:33920
    ds_read_b64_tr_b16 v[236:237], v219 offset:33792
    ds_read_b64_tr_b16 v[238:239], v219 offset:33920
    v_lshlrev_b32 v24, 16, v36
    v_and_b32 v25, s100, v36
    v_add_f32 v18, v18, v24
    v_add_f32 v19, v19, v25
    v_mfma_f32_32x32x16_bf16 v[192:207], v[36:39], v[148:151], v[192:207]
    v_lshlrev_b32 v26, 16, v37
    v_and_b32 v27, s100, v37
    v_add_f32 v18, v18, v26
    v_add_f32 v19, v19, v27
    v_dot2c_f32_bf16 v20, s101, v144
    v_dot2c_f32_bf16 v21, v144, v144
    v_dot2c_f32_bf16 v20, s101, v145
    v_dot2c_f32_bf16 v21, v145, v145
    v_dot2c_f32_bf16 v20, s101, v146
    v_dot2c_f32_bf16 v21, v146, v146
    v_dot2c_f32_bf16 v20, s101, v147
    v_dot2c_f32_bf16 v21, v147, v147
    v_dot2c_f32_bf16 v20, s101, v148
    v_dot2c_f32_bf16 v21, v148, v148
    v_dot2c_f32_bf16 v20, s101, v149
    v_dot2c_f32_bf16 v21, v149, v149
    v_dot2c_f32_bf16 v20, s101, v150
    v_dot2c_f32_bf16 v21, v150, v150
    v_dot2c_f32_bf16 v20, s101, v151
    v_dot2c_f32_bf16 v21, v151, v151
    s_waitcnt lgkmcnt(0)
    s_waitcnt vmcnt(5)
    s_barrier
    v_mfma_f32_32x32x16_bf16 v[176:191], v[40:43], v[152:155], v[176:191]
    ds_read_b128 v[160:163], v228 offset:0
    ds_read_b64_tr_b16 v[32:33], v212 offset:0
    ds_read_b64_tr_b16 v[34:35], v212 offset:128
    ds_read_b64_tr_b16 v[36:37], v220 offset:0
    ds_read_b64_tr_b16 v[38:39], v220 offset:128
    v_lshlrev_b32 v24, 16, v42
    v_and_b32 v25, s100, v42
    v_add_f32 v16, v16, v24
    v_add_f32 v17, v17, v25
    v_mfma_f32_32x32x16_bf16 v[192:207], v[44:47], v[152:155], v[192:207]
    v_lshlrev_b32 v26, 16, v43
    v_and_b32 v27, s100, v43
    v_add_f32 v16, v16, v26
    v_add_f32 v17, v17, v27
    s_add_u32 m0, s6, 33792
    s_nop 0
    global_load_lds_dwordx4 v[50:51], off
    v_lshl_add_u64 v[50:51], v[50:51], 0, v[54:55]
    s_waitcnt lgkmcnt(5)
    v_mfma_f32_32x32x16_bf16 v[176:191], v[232:235], v[156:159], v[176:191]
    ds_read_b128 v[164:167], v229 offset:0
    ds_read_b64_tr_b16 v[40:41], v213 offset:0
    ds_read_b64_tr_b16 v[42:43], v213 offset:128
    ds_read_b64_tr_b16 v[44:45], v221 offset:0
    ds_read_b64_tr_b16 v[46:47], v221 offset:128
    v_lshlrev_b32 v24, 16, v238
    v_and_b32 v25, s100, v238
    v_add_f32 v18, v18, v24
    v_add_f32 v19, v19, v25
    v_mfma_f32_32x32x16_bf16 v[192:207], v[236:239], v[156:159], v[192:207]
    v_lshlrev_b32 v26, 16, v239
    v_and_b32 v27, s100, v239
    v_add_f32 v18, v18, v26
    v_add_f32 v19, v19, v27
    s_add_u32 m0, s6, 42496
    s_nop 0
    global_load_lds_dwordx4 v[50:51], off
    s_add_u32 s98, s98, 1
    s_cmp_eq_u32 s98, 7
    s_cbranch_scc1 WR_33
    v_lshl_add_u64 v[50:51], v[50:51], 0, v[54:55]
    s_branch WD_34
WR_33:
    v_lshl_add_u64 v[50:51], v[50:51], 0, v[242:243]
    s_mov_b32 s98, 0
WD_34:
    s_waitcnt lgkmcnt(5)
    v_mfma_f32_32x32x16_bf16 v[176:191], v[32:35], v[160:163], v[176:191]
    ds_read_b128 v[168:171], v230 offset:0
    ds_read_b64_tr_b16 v[232:233], v214 offset:0
    ds_read_b64_tr_b16 v[234:235], v214 offset:128
    ds_read_b64_tr_b16 v[236:237], v222 offset:0
    ds_read_b64_tr_b16 v[238:239], v222 offset:128
    v_lshlrev_b32 v24, 16, v32
    v_and_b32 v25, s100, v32
    v_add_f32 v16, v16, v24
    v_add_f32 v17, v17, v25
    v_mfma_f32_32x32x16_bf16 v[192:207], v[36:39], v[160:163], v[192:207]
    v_lshlrev_b32 v26, 16, v33
    v_and_b32 v27, s100, v33
    v_add_f32 v16, v16, v26
    v_add_f32 v17, v17, v27
    s_waitcnt lgkmcnt(5)
    v_mfma_f32_32x32x16_bf16 v[176:191], v[40:43], v[164:167], v[176:191]
    ds_read_b128 v[172:175], v231 offset:0
    ds_read_b64_tr_b16 v[32:33], v215 offset:0
    ds_read_b64_tr_b16 v[34:35], v215 offset:128
    ds_read_b64_tr_b16 v[36:37], v223 offset:0
    ds_read_b64_tr_b16 v[38:39], v223 offset:128
    v_lshlrev_b32 v24, 16, v44
    v_and_b32 v25, s100, v44
    v_add_f32 v18, v18, v24
    v_add_f32 v19, v19, v25
    v_mfma_f32_32x32x16_bf16 v[192:207], v[44:47], v[164:167], v[192:207]
    v_lshlrev_b32 v26, 16, v45
    v_and_b32 v27, s100, v45
    v_add_f32 v18, v18, v26
    v_add_f32 v19, v19, v27
    v_dot2c_f32_bf16 v20, s101, v160
    v_dot2c_f32_bf16 v21, v160, v160
    v_dot2c_f32_bf16 v20, s101, v161
    v_dot2c_f32_bf16 v21, v161, v161
    v_dot2c_f32_bf16 v20, s101, v162
    v_dot2c_f32_bf16 v21, v162, v162
    v_dot2c_f32_bf16 v20, s101, v163
    v_dot2c_f32_bf16 v21, v163, v163
    v_dot2c_f32_bf16 v20, s101, v164
    v_dot2c_f32_bf16 v21, v164, v164
    v_dot2c_f32_bf16 v20, s101, v165
    v_dot2c_f32_bf16 v21, v165, v165
    v_dot2c_f32_bf16 v20, s101, v166
    v_dot2c_f32_bf16 v21, v166, v166
    v_dot2c_f32_bf16 v20, s101, v167
    v_dot2c_f32_bf16 v21, v167, v167
    v_add_u32 v208, v23, v208
    v_add_u32 v209, v23, v209
    v_add_u32 v210, v23, v210
    v_add_u32 v211, v23, v211
    v_add_u32 v212, v23, v212
    v_add_u32 v213, v23, v213
    v_add_u32 v214, v23, v214
    v_add_u32 v215, v23, v215
    s_waitcnt lgkmcnt(0)
    s_waitcnt vmcnt(5)
    s_barrier
    v_mfma_f32_32x32x16_bf16 v[176:191], v[232:235], v[168:171], v[176:191]
    ds_read_b64_tr_b16 v[40:41], v212 offset:33792
    ds_read_b64_tr_b16 v[42:43], v212 offset:33920
    ds_read_b64_tr_b16 v[44:45], v212 offset:33824
    ds_read_b64_tr_b16 v[46:47], v212 offset:33952
    v_lshlrev_b32 v24, 16, v234
    v_and_b32 v25, s100, v234
    v_add_f32 v16, v16, v24
    v_add_f32 v17, v17, v25
    v_mfma_f32_32x32x16_bf16 v[192:207], v[236:239], v[168:171], v[192:207]
    v_lshlrev_b32 v26, 16, v235
    v_and_b32 v27, s100, v235
    v_add_f32 v16, v16, v26
    v_add_f32 v17, v17, v27
    s_add_u32 m0, s6, 67584
    s_nop 0
    global_load_lds_dwordx4 v[50:51], off
    v_lshl_add_u64 v[50:51], v[50:51], 0, v[54:55]
    s_waitcnt lgkmcnt(4)
    v_mfma_f32_32x32x16_bf16 v[176:191], v[32:35], v[172:175], v[176:191]
    ds_read_b64_tr_b16 v[232:233], v213 offset:33792
    ds_read_b64_tr_b16 v[234:235], v213 offset:33920
    ds_read_b64_tr_b16 v[236:237], v213 offset:33824
    ds_read_b64_tr_b16 v[238:239], v213 offset:33952
    v_lshlrev_b32 v24, 16, v38
    v_and_b32 v25, s100, v38
    v_add_f32 v18, v18, v24
    v_add_f32 v19, v19, v25
    v_mfma_f32_32x32x16_bf16 v[192:207], v[36:39], v[172:175], v[192:207]
    v_lshlrev_b32 v26, 16, v39
    v_and_b32 v27, s100, v39
    v_add_f32 v18, v18, v26
    v_add_f32 v19, v19, v27
    s_add_u32 m0, s6, 76288
    s_nop 0
    global_load_lds_dwordx4 v[50:51], off
    s_add_u32 s98, s98, 1
    s_cmp_eq_u32 s98, 7
    s_cbranch_scc1 WR_35
    v_lshl_add_u64 v[50:51], v[50:51], 0, v[54:55]
    s_branch WD_36
WR_35:
    v_lshl_add_u64 v[50:51], v[50:51], 0, v[242:243]
    s_mov_b32 s98, 0
WD_36:
    v_readfirstlane_b32 s57, v3
    s_mov_b32 s60, 0
    s_cmp_lg_u32 s57, 0
    s_cbranch_scc1 ND_44
NL_43:
    buffer_load_dword v3, v2, s[52:55], 0 offen sc1
    s_waitcnt vmcnt(0)
    v_readfirstlane_b32 s57, v3
    s_add_u32 s60, s60, 1
    s_cmp_lg_u32 s57, 0
    s_cbranch_scc1 ND_44
    s_cmp_lt_u32 s60, 0x100000
    s_cbranch_scc1 NL_43
ND_44:
    v_lshlrev_b32 v5, 4, v1
    s_lshl_b32 s60, s69, 11
    s_add_u32 s60, s60, 135168
    v_add_u32 v7, s60, v5
    s_lshl_b32 s60, s68, 2
    v_add_u32 v6, s60, v7
    v_add_f32 v16, v16, v17
    v_add_f32 v18, v18, v19
    ds_write_b32 v6, v16
    ds_write_b32 v6, v18 offset:1024
    s_lshl_b32 s60, s68, 10
    s_add_u32 s60, s60, 139264
    v_add_u32 v9, s60, v5
    s_lshl_b32 s60, s69, 3
    v_add_u32 v8, s60, v9
    ds_write_b64 v8, v[20:21]
    s_waitcnt lgkmcnt(0)
    s_barrier
    ds_read_b128 v[24:27], v9
    ds_read_b128 v[8:11], v7
    ds_read_b128 v[12:15], v7 offset:1024
    v_mov_b32 v16, 0
    v_mov_b32 v17, 0
    v_mov_b32 v18, 0
    v_mov_b32 v19, 0
    s_waitcnt lgkmcnt(2)
    v_add_f32 v20, v24, v26
    v_add_f32 v21, v25, v27
    v_mov_b32 v24, v20
    v_mov_b32 v25, v21
    s_nop 1
    v_permlane32_swap_b32 v20, v24
    v_permlane32_swap_b32 v21, v25
    s_mov_b32 s60, 0x3b124925
    v_add_f32 v20, v20, v24
    v_add_f32 v21, v21, v25
    v_mul_f32 v24, s60, v20
    v_mul_f32 v25, s60, v21
    v_fma_f32 v25, -v24, v24, v25
    v_max_f32 v25, 0, v25
    v_cvt_pk_bf16_f32 v26, v24, v25
    v_and_b32 v25, 0xffff0000, v26
    v_add_f32 v25, 0x3727c5ac, v25
    v_cvt_pk_bf16_f32 v25, v25, v25
    v_and_b32 v25, 0xffff0000, v25
    v_sqrt_f32 v25, v25
    v_and_b32 v26, 0xffff, v26
    v_cvt_pk_bf16_f32 v25, v25, v25
    v_and_b32 v25, 0xffff0000, v25
    v_rcp_f32 v22, v25
    v_xor_b32 v58, 0x8000, v26
    v_mov_b32 v59, v58
    v_mov_b32 v60, 0
    v_mov_b32 v61, 0
    s_waitcnt lgkmcnt(1)
    v_add_f32 v8, v8, v9
    v_add_f32 v10, v10, v11
    v_add_f32 v8, v8, v10
    v_cvt_pk_bf16_f32 v24, v8, v8
    v_and_b32 v9, 0xffff0000, v24
    v_sub_f32 v8, v8, v9
    v_cvt_pk_bf16_f32 v25, v8, v8
    v_mov_b32 v26, 0
    v_mov_b32 v27, 0
    s_nop 1
    v_mfma_f32_32x32x16_bf16 v[176:191], v[24:27], v[58:61], v[176:191]
    s_waitcnt lgkmcnt(0)
    v_add_f32 v12, v12, v13
    v_add_f32 v14, v14, v15
    v_add_f32 v12, v12, v14
    v_cvt_pk_bf16_f32 v28, v12, v12
    v_and_b32 v13, 0xffff0000, v28
    v_sub_f32 v12, v12, v13
    v_cvt_pk_bf16_f32 v29, v12, v12
    v_mov_b32 v30, 0
    v_mov_b32 v31, 0
    s_nop 1
    v_mfma_f32_32x32x16_bf16 v[192:207], v[28:31], v[58:61], v[192:207]
    s_lshl_b32 s60, s66, 2
    s_add_u32 s60, s60, s68
    s_cmp_lt_u32 s67, 4
    s_cbranch_scc1 L_EPI_QKV
    s_sub_u32 s63, s67, 4
    s_mul_i32 s61, s60, 114688
    s_lshl_b32 s62, s63, 12
    s_add_u32 s61, s61, s62
    s_lshl_b32 s62, s69, 11
    s_add_u32 s61, s61, s62
    s_nop 4
    v_max_f32 v176, 0, v176
    v_max_f32 v177, 0, v177
    v_max_f32 v178, 0, v178
    v_max_f32 v179, 0, v179
    v_max_f32 v180, 0, v180
    v_max_f32 v181, 0, v181
    v_max_f32 v182, 0, v182
    v_max_f32 v183, 0, v183
    v_mul_f32 v176, v176, v184
    v_mul_f32 v177, v177, v185
    v_mul_f32 v178, v178, v186
    v_mul_f32 v179, v179, v187
    v_mul_f32 v180, v180, v188
    v_mul_f32 v181, v181, v189
    v_mul_f32 v182, v182, v190
    v_mul_f32 v183, v183, v191
    v_cvt_pk_bf16_f32 v8, v176, v177
    v_cvt_pk_bf16_f32 v9, v178, v179
    v_cvt_pk_bf16_f32 v10, v180, v181
    v_cvt_pk_bf16_f32 v11, v182, v183
    buffer_store_dwordx4 v[8:11], v5, s[36:39], s61 offen offset:0 sc1
    v_max_f32 v192, 0, v192
    v_max_f32 v193, 0, v193
    v_max_f32 v194, 0, v194
    v_max_f32 v195, 0, v195
    v_max_f32 v196, 0, v196
    v_max_f32 v197, 0, v197
    v_max_f32 v198, 0, v198
    v_max_f32 v199, 0, v199
    v_mul_f32 v192, v192, v200
    v_mul_f32 v193, v193, v201
    v_mul_f32 v194, v194, v202
    v_mul_f32 v195, v195, v203
    v_mul_f32 v196, v196, v204
    v_mul_f32 v197, v197, v205
    v_mul_f32 v198, v198, v206
    v_mul_f32 v199, v199, v207
    v_cvt_pk_bf16_f32 v12, v192, v193
    v_cvt_pk_bf16_f32 v13, v194, v195
    v_cvt_pk_bf16_f32 v14, v196, v197
    v_cvt_pk_bf16_f32 v15, v198, v199
    buffer_store_dwordx4 v[12:15], v5, s[36:39], s61 offen offset:1024 sc1
    s_branch L_EPIA_DONE
L_EPI_QKV:
    v_mul_f32 v4, 0x3e8b97f6, v22
    v_mov_b32 v6, v4
    s_mov_b32 exec_lo, 0
    v_mov_b32 v6, v22
    s_mov_b64 exec, -1
    s_lshl_b32 s62, s67, 1
    s_add_u32 s62, s62, s69
    s_lshl_b32 s61, s66, 17
    s_lshl_b32 s63, s62, 14
    s_add_u32 s61, s61, s63
    s_lshl_b32 s63, s68, 11
    s_add_u32 s61, s61, s63
    s_add_u32 s61, s61, 7340032
    s_add_u32 s65, s61, 8192
    s_cmp_lg_u32 s62, 0
    s_cbranch_scc1 L_NO_R2
    v_mul_f32 v8, v22, v22
    v_and_b32 v9, 31, v1
    v_lshlrev_b32 v9, 2, v9
    s_lshl_b32 s64, s60, 7
    s_add_u32 s64, s64, 9699328
    buffer_store_dword v8, v9, s[36:39], s64 offen sc1
L_NO_R2:
    v_mul_f32 v176, v4, v176
    v_mul_f32 v177, v4, v177
    v_mul_f32 v178, v4, v178
    v_mul_f32 v179, v4, v179
    v_mul_f32 v180, v4, v180
    v_mul_f32 v181, v4, v181
    v_mul_f32 v182, v4, v182
    v_mul_f32 v183, v4, v183
    v_mul_f32 v184, v6, v184
    v_mul_f32 v185, v6, v185
    v_mul_f32 v186, v6, v186
    v_mul_f32 v187, v6, v187
    v_mul_f32 v188, v4, v188
    v_mul_f32 v189, v4, v189
    v_mul_f32 v190, v4, v190
    v_mul_f32 v191, v4, v191
    v_cvt_pk_bf16_f32 v24, v176, v177
    v_cvt_pk_bf16_f32 v25, v178, v179
    v_cvt_pk_bf16_f32 v26, v180, v181
    v_cvt_pk_bf16_f32 v27, v182, v183
    v_cvt_pk_bf16_f32 v28, v184, v185
    v_cvt_pk_bf16_f32 v29, v186, v187
    v_cvt_pk_bf16_f32 v30, v188, v189
    v_cvt_pk_bf16_f32 v31, v190, v191
    v_mov_b32 v14, v28
    v_mov_b32 v15, v29
    v_mul_f32 v192, v4, v192
    v_mul_f32 v193, v4, v193
    v_mul_f32 v194, v4, v194
    v_mul_f32 v195, v4, v195
    v_mul_f32 v196, v4, v196
    v_mul_f32 v197, v4, v197
    v_mul_f32 v198, v4, v198
    v_mul_f32 v199, v4, v199
    v_mul_f32 v200, v6, v200
    v_mul_f32 v201, v6, v201
    v_mul_f32 v202, v6, v202
    v_mul_f32 v203, v6, v203
    v_mul_f32 v204, v4, v204
    v_mul_f32 v205, v4, v205
    v_mul_f32 v206, v4, v206
    v_mul_f32 v207, v4, v207
    v_cvt_pk_bf16_f32 v32, v192, v193
    v_cvt_pk_bf16_f32 v33, v194, v195
    v_cvt_pk_bf16_f32 v34, v196, v197
    v_cvt_pk_bf16_f32 v35, v198, v199
    v_cvt_pk_bf16_f32 v36, v200, v201
    v_cvt_pk_bf16_f32 v37, v202, v203
    v_cvt_pk_bf16_f32 v38, v204, v205
    v_cvt_pk_bf16_f32 v39, v206, v207
    v_mov_b32 v12, v36
    v_mov_b32 v13, v37
    s_and_b32 s63, s62, 3
    s_mov_b32 exec_lo, 0
    v_mov_b32 v28, 0
    v_mov_b32 v29, 0
    v_mov_b32 v36, 0
    v_mov_b32 v37, 0
    s_mov_b64 exec, -1
    s_cmp_lg_u32 s63, 3
    s_cbranch_scc1 L_NOPAD
    v_mov_b32 v12, 0x3f80
    v_mov_b32 v13, 0
L_NOPAD:
    buffer_store_dwordx4 v[24:27], v5, s[36:39], s61 offen sc1
    buffer_store_dwordx4 v[28:31], v5, s[36:39], s61 offen offset:1024 sc1
    buffer_store_dwordx4 v[32:35], v5, s[36:39], s65 offen sc1
    buffer_store_dwordx4 v[36:39], v5, s[36:39], s65 offen offset:1024 sc1
    s_lshl_b32 s61, s60, 12
    s_add_u32 s61, s61, 9437184
    v_and_b32 v8, 31, v1
    v_lshlrev_b32 v8, 4, v8
    s_cmp_ge_u32 s67, 2
    s_cbranch_scc1 L_EPI_V
    s_lshl_b32 s64, s63, 9
    s_add_u32 s61, s61, s64
    s_mov_b32 exec_lo, 0
    buffer_store_dwordx4 v[12:15], v8, s[36:39], s61 offen sc1
    s_mov_b64 exec, -1
    s_branch L_EPIA_DONE
L_EPI_V:
    s_lshl_b32 s64, s56, 9
    s_add_u32 s64, s64, 143360
    v_add_u32 v8, s64, v8
    s_mov_b32 exec_lo, 0
    ds_write_b128 v8, v[12:15]
    s_mov_b64 exec, -1
    v_bfe_u32 v9, v1, 4, 1
    v_lshlrev_b32 v8, 8, v9
    v_bfe_u32 v10, v1, 1, 1
    v_lshl_add_u32 v8, v10, 6, v8
    v_bfe_u32 v10, v1, 2, 2
    v_lshl_add_u32 v8, v10, 4, v8
    v_and_b32 v10, 1, v1
    v_lshl_add_u32 v8, v10, 3, v8
    v_add_u32 v8, s64, v8
    s_waitcnt lgkmcnt(0)
    ds_read_b64_tr_b16 v[12:13], v8
    ds_read_b64_tr_b16 v[14:15], v8 offset:128
    v_lshlrev_b32 v8, 10, v9
    v_bfe_u32 v10, v1, 3, 1
    v_lshl_add_u32 v8, v10, 9, v8
    v_and_b32 v11, 7, v1
    s_lshl_b32 s65, s63, 3
    v_add_u32 v11, s65, v11
    v_cmp_le_u32 vcc, 28, v11
    v_subrev_u32 v10, 4, v11
    s_nop 0
    v_cndmask_b32 v10, v11, v10, vcc
    v_cmp_le_u32 vcc, 11, v10
    s_nop 1
    v_addc_co_u32 v9, vcc, 0, v10, vcc
    v_cmp_le_u32 vcc, 14, v10
    s_nop 1
    v_addc_co_u32 v9, vcc, 0, v9, vcc
    v_cmp_le_u32 vcc, 25, v10
    s_nop 1
    v_addc_co_u32 v9, vcc, 0, v9, vcc
    v_and_b32 v10, 1, v11
    v_lshlrev_b32 v10, 2, v10
    v_bfe_u32 v4, v11, 1, 1
    v_lshl_add_u32 v10, v4, 4, v10
    v_add_u32 v10, 11, v10
    v_and_b32 v11, 28, v11
    v_cmp_eq_u32 vcc, 24, v11
    s_nop 1
    v_cndmask_b32 v9, v9, v10, vcc
    v_lshl_add_u32 v8, v9, 4, v8
    s_waitcnt lgkmcnt(0)
    s_mov_b32 exec_hi, 0
    buffer_store_dwordx4 v[12:15], v8, s[36:39], s61 offen offset:2048 sc1
    s_mov_b64 exec, -1
L_EPIA_DONE:
    s_min_u32 s62, s59, 27
    s_mul_i32 s60, s62, 37
    s_lshr_b32 s60, s60, 8
    s_mul_i32 s61, s60, 7
    s_sub_u32 s14, s62, s61
    s_lshl_b32 s13, s58, 2
    s_add_u32 s13, s13, s60
    s_lshl_b32 s22, s60, 1
    s_add_u32 s22, s22, s14
    s_lshl_b32 s22, s22, 1
    s_and_b32 s22, s22, 15
    s_mul_i32 s15, s68, 172032
    s_lshl_b32 s60, s14, 7
    s_add_u32 s15, s15, s60
    s_mul_i32 s16, s68, 33792
    s_add_u32 s16, s16, 17408
    v_lshrrev_b32 v8, 3, v1
    v_bfe_u32 v9, v1, 4, 1
    v_lshlrev_b32 v9, 2, v9
    v_and_b32 v10, 7, v1
    v_xor_b32 v9, v9, v10
    v_mul_u32_u24 v8, 896, v8
    v_lshl_add_u32 v62, v9, 4, v8
    v_lshlrev_b32 v63, 4, v1
    s_cmp_ge_u32 s56, 4
    s_cbranch_scc1 L_RS_G
    s_lshr_b32 s60, s59, 4
    s_lshl_b32 s17, s58, 1
    s_add_u32 s17, s17, s60
    s_and_b32 s18, s59, 15
    s_lshl_b32 s20, s56, 16
    s_add_u32 s20, s20, 9437184
    s_and_b32 s19, s18, 3
    s_lshl_b32 s19, s19, 14
    s_add_u32 s8, s20, s19
    s_add_u32 s19, s19, 12288
    s_add_u32 s21, s20, s19
    s_lshl_b32 s60, s17, 4
    s_add_u32 s60, s60, s18
    s_lshl_b32 s60, s60, 13
    s_add_u32 s30, s60, 7340032
    s_lshl_b32 s31, s56, 11
    s_movk_i32 s5, 0x1fff
    s_add_u32 s9, s30, s31
    s_mov_b32 s11, s21
    v_and_b32 v8, 3, v1
    v_bfe_u32 v9, v1, 2, 2
    v_lshl_add_u32 v8, v9, 4, v8
    v_lshlrev_b32 v8, 2, v8
    s_lshl_b32 s60, s56, 8
    v_add_u32 v2, s60, v8
    s_lshl_b32 s60, s17, 6
    s_lshr_b32 s61, s18, 2
    s_lshl_b32 s61, s61, 2
    s_add_u32 s60, s60, s61
    s_mov_b32 exec_lo, 0
    v_mov_b32 v2, s60
    s_lshl_b32 s60, s17, 6
    s_lshl_b32 s61, s18, 2
    s_add_u32 s60, s60, s61
    s_mov_b32 exec_hi, 0xffff0000
    v_mov_b32 v2, s60
    s_mov_b64 exec, -1
    s_mov_b32 s10, 11804672
    s_branch L_RS_DONE
L_RS_G:
    s_mul_i32 s8, s13, 229376
    s_mul_i32 s60, s68, 12288
    s_add_u32 s8, s8, s60
    s_add_u32 s9, s8, 114688
    s_mov_b32 s30, s9
    s_mov_b32 s31, 0
    s_mov_b32 s5, -1
    s_add_u32 s11, s9, 8192
    v_min_u32 v8, 3, v1
    s_mul_i32 s60, s68, 3
    s_add_u32 s60, s60, 4
    v_add_u32 v8, s60, v8
    v_cmp_gt_u32 vcc, 3, v1
    s_lshr_b32 s61, s13, 1
    s_lshl_b32 s61, s61, 6
    v_cndmask_b32 v8, 0, v8, vcc
    v_lshlrev_b32 v2, 2, v8
    s_add_u32 s10, s61, 11804672
L_RS_DONE:
    s_waitcnt lgkmcnt(4)
    v_mfma_f32_32x32x16_bf16 v[176:191], v[40:43], v[64:67], 0
    ds_read_b64_tr_b16 v[32:33], v214 offset:33792
    ds_read_b64_tr_b16 v[34:35], v214 offset:33920
    ds_read_b64_tr_b16 v[36:37], v214 offset:33824
    ds_read_b64_tr_b16 v[38:39], v214 offset:33952
    v_lshlrev_b32 v24, 16, v40
    v_and_b32 v25, s100, v40
    v_add_f32 v16, v16, v24
    v_add_f32 v17, v17, v25
    v_mfma_f32_32x32x16_bf16 v[192:207], v[44:47], v[64:67], 0
    v_lshlrev_b32 v26, 16, v41
    v_and_b32 v27, s100, v41
    v_add_f32 v16, v16, v26
    v_add_f32 v17, v17, v27
    s_waitcnt lgkmcnt(4)
    v_mfma_f32_32x32x16_bf16 v[176:191], v[232:235], v[68:71], v[176:191]
    ds_read_b64_tr_b16 v[40:41], v215 offset:33792
    ds_read_b64_tr_b16 v[42:43], v215 offset:33920
    ds_read_b64_tr_b16 v[44:45], v215 offset:33824
    ds_read_b64_tr_b16 v[46:47], v215 offset:33952
    v_lshlrev_b32 v24, 16, v236
    v_and_b32 v25, s100, v236
    v_add_f32 v18, v18, v24
    v_add_f32 v19, v19, v25
    v_mfma_f32_32x32x16_bf16 v[192:207], v[236:239], v[68:71], v[192:207]
    v_lshlrev_b32 v26, 16, v237
    v_and_b32 v27, s100, v237
    v_add_f32 v18, v18, v26
    v_add_f32 v19, v19, v27
    s_waitcnt lgkmcnt(0)
    s_waitcnt vmcnt(6)
    s_barrier
    v_mfma_f32_32x32x16_bf16 v[176:191], v[32:35], v[72:75], v[176:191]
    ds_read_b64_tr_b16 v[232:233], v208 offset:0
    ds_read_b64_tr_b16 v[234:235], v208 offset:128
    ds_read_b64_tr_b16 v[236:237], v208 offset:32
    ds_read_b64_tr_b16 v[238:239], v208 offset:160
    v_lshlrev_b32 v24, 16, v34
    v_and_b32 v25, s100, v34
    v_add_f32 v16, v16, v24
    v_add_f32 v17, v17, v25
    v_mfma_f32_32x32x16_bf16 v[192:207], v[36:39], v[72:75], v[192:207]
    v_lshlrev_b32 v26, 16, v35
    v_and_b32 v27, s100, v35
    v_add_f32 v16, v16, v26
    v_add_f32 v17, v17, v27
    s_add_u32 m0, s6, 101376
    s_nop 0
    global_load_lds_dwordx4 v[50:51], off
    v_lshl_add_u64 v[50:51], v[50:51], 0, v[54:55]
    s_waitcnt lgkmcnt(4)
    v_mfma_f32_32x32x16_bf16 v[176:191], v[40:43], v[76:79], v[176:191]
    ds_read_b64_tr_b16 v[32:33], v209 offset:0
    ds_read_b64_tr_b16 v[34:35], v209 offset:128
    ds_read_b64_tr_b16 v[36:37], v209 offset:32
    ds_read_b64_tr_b16 v[38:39], v209 offset:160
    v_lshlrev_b32 v24, 16, v46
    v_and_b32 v25, s100, v46
    v_add_f32 v18, v18, v24
    v_add_f32 v19, v19, v25
    v_mfma_f32_32x32x16_bf16 v[192:207], v[44:47], v[76:79], v[192:207]
    v_lshlrev_b32 v26, 16, v47
    v_and_b32 v27, s100, v47
    v_add_f32 v18, v18, v26
    v_add_f32 v19, v19, v27
    s_add_u32 m0, s6, 110080
    s_nop 0
    global_load_lds_dwordx4 v[50:51], off
    s_add_u32 s98, s98, 1
    s_cmp_eq_u32 s98, 7
    s_cbranch_scc1 WR_37
    v_lshl_add_u64 v[50:51], v[50:51], 0, v[54:55]
    s_branch WD_38
WR_37:
    v_lshl_add_u64 v[50:51], v[50:51], 0, v[242:243]
    s_mov_b32 s98, 0
WD_38:
    s_waitcnt lgkmcnt(4)
    v_mfma_f32_32x32x16_bf16 v[176:191], v[232:235], v[80:83], v[176:191]
    ds_read_b64_tr_b16 v[40:41], v210 offset:0
    ds_read_b64_tr_b16 v[42:43], v210 offset:128
    ds_read_b64_tr_b16 v[44:45], v210 offset:32
    ds_read_b64_tr_b16 v[46:47], v210 offset:160
    v_lshlrev_b32 v24, 16, v232
    v_and_b32 v25, s100, v232
    v_add_f32 v16, v16, v24
    v_add_f32 v17, v17, v25
    v_mfma_f32_32x32x16_bf16 v[192:207], v[236:239], v[80:83], v[192:207]
    v_lshlrev_b32 v26, 16, v233
    v_and_b32 v27, s100, v233
    v_add_f32 v16, v16, v26
    v_add_f32 v17, v17, v27
    s_waitcnt lgkmcnt(4)
    v_mfma_f32_32x32x16_bf16 v[176:191], v[32:35], v[84:87], v[176:191]
    ds_read_b64_tr_b16 v[232:233], v211 offset:0
    ds_read_b64_tr_b16 v[234:235], v211 offset:128
    ds_read_b64_tr_b16 v[236:237], v211 offset:32
    ds_read_b64_tr_b16 v[238:239], v211 offset:160
    v_lshlrev_b32 v24, 16, v36
    v_and_b32 v25, s100, v36
    v_add_f32 v18, v18, v24
    v_add_f32 v19, v19, v25
    v_mfma_f32_32x32x16_bf16 v[192:207], v[36:39], v[84:87], v[192:207]
    v_lshlrev_b32 v26, 16, v37
    v_and_b32 v27, s100, v37
    v_add_f32 v18, v18, v26
    v_add_f32 v19, v19, v27
    s_waitcnt lgkmcnt(0)
    s_waitcnt vmcnt(2)
    s_barrier
    s_cmp_lg_u32 s56, 0
    s_cbranch_scc1 L_NOFA
    s_lshl_b32 s60, s66, 6
    s_lshl_b32 s61, s67, 2
    s_add_u32 s60, s60, s61
    s_add_u32 s60, s60, 11804672
    v_mov_b32 v8, 0
    v_mov_b32 v9, s57
    buffer_store_dword v9, v8, s[36:39], s60 offen sc1
L_NOFA:
    v_mfma_f32_32x32x16_bf16 v[176:191], v[40:43], v[88:91], v[176:191]
    ds_read_b64_tr_b16 v[32:33], v208 offset:33792
    ds_read_b64_tr_b16 v[34:35], v208 offset:33920
    ds_read_b64_tr_b16 v[36:37], v208 offset:33824
    ds_read_b64_tr_b16 v[38:39], v208 offset:33952
    v_lshlrev_b32 v24, 16, v42
    v_and_b32 v25, s100, v42
    v_add_f32 v16, v16, v24
    v_add_f32 v17, v17, v25
    v_mfma_f32_32x32x16_bf16 v[192:207], v[44:47], v[88:91], v[192:207]
    v_lshlrev_b32 v26, 16, v43
    v_and_b32 v27, s100, v43
    v_add_f32 v16, v16, v26
    v_add_f32 v17, v17, v27
    s_add_u32 m0, s6, 0
    s_nop 0
    global_load_lds_dwordx4 v[50:51], off
    v_lshl_add_u64 v[50:51], v[50:51], 0, v[54:55]
    s_waitcnt lgkmcnt(4)
    v_mfma_f32_32x32x16_bf16 v[176:191], v[232:235], v[92:95], v[176:191]
    ds_read_b64_tr_b16 v[40:41], v209 offset:33792
    ds_read_b64_tr_b16 v[42:43], v209 offset:33920
    ds_read_b64_tr_b16 v[44:45], v209 offset:33824
    ds_read_b64_tr_b16 v[46:47], v209 offset:33952
    v_lshlrev_b32 v24, 16, v238
    v_and_b32 v25, s100, v238
    v_add_f32 v18, v18, v24
    v_add_f32 v19, v19, v25
    v_mfma_f32_32x32x16_bf16 v[192:207], v[236:239], v[92:95], v[192:207]
    v_lshlrev_b32 v26, 16, v239
    v_and_b32 v27, s100, v239
    v_add_f32 v18, v18, v26
    v_add_f32 v19, v19, v27
    s_add_u32 m0, s6, 8704
    s_nop 0
    global_load_lds_dwordx4 v[50:51], off
    s_add_u32 s98, s98, 1
    s_cmp_eq_u32 s98, 7
    s_cbranch_scc1 WR_39
    v_lshl_add_u64 v[50:51], v[50:51], 0, v[54:55]
    s_branch WD_40
WR_39:
    v_lshl_add_u64 v[50:51], v[50:51], 0, v[242:243]
    s_mov_b32 s98, 0
WD_40:
    s_waitcnt lgkmcnt(4)
    v_mfma_f32_32x32x16_bf16 v[176:191], v[32:35], v[96:99], v[176:191]
    ds_read_b64_tr_b16 v[232:233], v210 offset:33792
    ds_read_b64_tr_b16 v[234:235], v210 offset:33920
    ds_read_b64_tr_b16 v[236:237], v210 offset:33824
    ds_read_b64_tr_b16 v[238:239], v210 offset:33952
    v_lshlrev_b32 v24, 16, v32
    v_and_b32 v25, s100, v32
    v_add_f32 v16, v16, v24
    v_add_f32 v17, v17, v25
    v_mfma_f32_32x32x16_bf16 v[192:207], v[36:39], v[96:99], v[192:207]
    v_lshlrev_b32 v26, 16, v33
    v_and_b32 v27, s100, v33
    v_add_f32 v16, v16, v26
    v_add_f32 v17, v17, v27
    s_waitcnt lgkmcnt(4)
    v_mfma_f32_32x32x16_bf16 v[176:191], v[40:43], v[100:103], v[176:191]
    ds_read_b64_tr_b16 v[32:33], v211 offset:33792
    ds_read_b64_tr_b16 v[34:35], v211 offset:33920
    ds_read_b64_tr_b16 v[36:37], v211 offset:33824
    ds_read_b64_tr_b16 v[38:39], v211 offset:33952
    v_lshlrev_b32 v24, 16, v44
    v_and_b32 v25, s100, v44
    v_add_f32 v18, v18, v24
    v_add_f32 v19, v19, v25
    v_mfma_f32_32x32x16_bf16 v[192:207], v[44:47], v[100:103], v[192:207]
    v_lshlrev_b32 v26, 16, v45
    v_and_b32 v27, s100, v45
    v_add_f32 v18, v18, v26
    v_add_f32 v19, v19, v27
    s_waitcnt lgkmcnt(0)
    s_waitcnt vmcnt(63)
    s_barrier
    v_mfma_f32_32x32x16_bf16 v[176:191], v[232:235], v[104:107], v[176:191]
    ds_read_b64_tr_b16 v[40:41], v212 offset:0
    ds_read_b64_tr_b16 v[42:43], v212 offset:128
    ds_read_b64_tr_b16 v[44:45], v212 offset:32
    ds_read_b64_tr_b16 v[46:47], v212 offset:160
    v_lshlrev_b32 v24, 16, v234
    v_and_b32 v25, s100, v234
    v_add_f32 v16, v16, v24
    v_add_f32 v17, v17, v25
    v_mfma_f32_32x32x16_bf16 v[192:207], v[236:239], v[104:107], v[192:207]
    v_lshlrev_b32 v26, 16, v235
    v_and_b32 v27, s100, v235
    v_add_f32 v16, v16, v26
    v_add_f32 v17, v17, v27
    s_add_u32 m0, s6, 33792
    s_nop 0
    global_load_lds_dwordx4 v[50:51], off
    v_lshl_add_u64 v[50:51], v[50:51], 0, v[54:55]
    s_waitcnt lgkmcnt(4)
    v_mfma_f32_32x32x16_bf16 v[176:191], v[32:35], v[108:111], v[176:191]
    ds_read_b64_tr_b16 v[232:233], v213 offset:0
    ds_read_b64_tr_b16 v[234:235], v213 offset:128
    ds_read_b64_tr_b16 v[236:237], v213 offset:32
    ds_read_b64_tr_b16 v[238:239], v213 offset:160
    v_lshlrev_b32 v24, 16, v38
    v_and_b32 v25, s100, v38
    v_add_f32 v18, v18, v24
    v_add_f32 v19, v19, v25
    v_mfma_f32_32x32x16_bf16 v[192:207], v[36:39], v[108:111], v[192:207]
    v_lshlrev_b32 v26, 16, v39
    v_and_b32 v27, s100, v39
    v_add_f32 v18, v18, v26
    v_add_f32 v19, v19, v27
    s_add_u32 m0, s6, 42496
    s_nop 0
    global_load_lds_dwordx4 v[50:51], off
    s_add_u32 s98, s98, 1
    s_cmp_eq_u32 s98, 7
    s_cbranch_scc1 WR_41
    v_lshl_add_u64 v[50:51], v[50:51], 0, v[54:55]
    s_branch WD_42
WR_41:
    v_lshl_add_u64 v[50:51], v[50:51], 0, v[242:243]
    s_mov_b32 s98, 0
WD_42:
    s_waitcnt lgkmcnt(4)
    v_mfma_f32_32x32x16_bf16 v[176:191], v[40:43], v[112:115], v[176:191]
    ds_read_b64_tr_b16 v[32:33], v214 offset:0
    ds_read_b64_tr_b16 v[34:35], v214 offset:128
    ds_read_b64_tr_b16 v[36:37], v214 offset:32
    ds_read_b64_tr_b16 v[38:39], v214 offset:160
    v_lshlrev_b32 v24, 16, v40
    v_and_b32 v25, s100, v40
    v_add_f32 v16, v16, v24
    v_add_f32 v17, v17, v25
    v_mfma_f32_32x32x16_bf16 v[192:207], v[44:47], v[112:115], v[192:207]
    v_lshlrev_b32 v26, 16, v41
    v_and_b32 v27, s100, v41
    v_add_f32 v16, v16, v26
    v_add_f32 v17, v17, v27
    s_waitcnt lgkmcnt(4)
    v_mfma_f32_32x32x16_bf16 v[176:191], v[232:235], v[116:119], v[176:191]
    ds_read_b64_tr_b16 v[40:41], v215 offset:0
    ds_read_b64_tr_b16 v[42:43], v215 offset:128
    ds_read_b64_tr_b16 v[44:45], v215 offset:32
    ds_read_b64_tr_b16 v[46:47], v215 offset:160
    v_lshlrev_b32 v24, 16, v236
    v_and_b32 v25, s100, v236
    v_add_f32 v18, v18, v24
    v_add_f32 v19, v19, v25
    v_mfma_f32_32x32x16_bf16 v[192:207], v[236:239], v[116:119], v[192:207]
    v_lshlrev_b32 v26, 16, v237
    v_and_b32 v27, s100, v237
    v_add_f32 v18, v18, v26
    v_add_f32 v19, v19, v27
    s_waitcnt lgkmcnt(0)
    s_waitcnt vmcnt(4)
    s_barrier
    v_mfma_f32_32x32x16_bf16 v[176:191], v[32:35], v[120:123], v[176:191]
    ds_read_b64_tr_b16 v[232:233], v212 offset:33792
    ds_read_b64_tr_b16 v[234:235], v212 offset:33920
    ds_read_b64_tr_b16 v[236:237], v212 offset:33824
    ds_read_b64_tr_b16 v[238:239], v212 offset:33952
    v_lshlrev_b32 v24, 16, v34
    v_and_b32 v25, s100, v34
    v_add_f32 v16, v16, v24
    v_add_f32 v17, v17, v25
    v_mfma_f32_32x32x16_bf16 v[192:207], v[36:39], v[120:123], v[192:207]
    v_lshlrev_b32 v26, 16, v35
    v_and_b32 v27, s100, v35
    v_add_f32 v16, v16, v26
    v_add_f32 v17, v17, v27
    s_waitcnt lgkmcnt(4)
    v_mfma_f32_32x32x16_bf16 v[176:191], v[40:43], v[124:127], v[176:191]
    ds_read_b64_tr_b16 v[32:33], v213 offset:33792
    ds_read_b64_tr_b16 v[34:35], v213 offset:33920
    ds_read_b64_tr_b16 v[36:37], v213 offset:33824
    ds_read_b64_tr_b16 v[38:39], v213 offset:33952
    v_lshlrev_b32 v24, 16, v46
    v_and_b32 v25, s100, v46
    v_add_f32 v18, v18, v24
    v_add_f32 v19, v19, v25
    v_mfma_f32_32x32x16_bf16 v[192:207], v[44:47], v[124:127], v[192:207]
    v_lshlrev_b32 v26, 16, v47
    v_and_b32 v27, s100, v47
    v_add_f32 v18, v18, v26
    v_add_f32 v19, v19, v27
    s_waitcnt vmcnt(0)
    s_cmp_eq_u32 s69, 0
    s_cbranch_scc1 PFS_45
    s_add_u32 m0, s16, 0
    s_add_u32 s60, s15, 0
    buffer_load_dwordx4 v62, s[40:43], s60 offen lds
    s_add_u32 m0, s16, 1024
    s_add_u32 s60, s15, 7168
    buffer_load_dwordx4 v62, s[40:43], s60 offen lds
PFS_45:
    s_waitcnt lgkmcnt(4)
    v_mfma_f32_32x32x16_bf16 v[176:191], v[232:235], v[128:131], v[176:191]
    ds_read_b64_tr_b16 v[40:41], v214 offset:33792
    ds_read_b64_tr_b16 v[42:43], v214 offset:33920
    ds_read_b64_tr_b16 v[44:45], v214 offset:33824
    ds_read_b64_tr_b16 v[46:47], v214 offset:33952
    v_lshlrev_b32 v24, 16, v232
    v_and_b32 v25, s100, v232
    v_add_f32 v16, v16, v24
    v_add_f32 v17, v17, v25
    v_mfma_f32_32x32x16_bf16 v[192:207], v[236:239], v[128:131], v[192:207]
    v_lshlrev_b32 v26, 16, v233
    v_and_b32 v27, s100, v233
    v_add_f32 v16, v16, v26
    v_add_f32 v17, v17, v27
    s_cmp_eq_u32 s69, 0
    s_cbranch_scc1 PFS_46
    s_add_u32 m0, s16, 2048
    s_add_u32 s60, s15, 14336
    buffer_load_dwordx4 v62, s[40:43], s60 offen lds
    s_add_u32 m0, s16, 3072
    s_add_u32 s60, s15, 21504
    buffer_load_dwordx4 v62, s[40:43], s60 offen lds
    s_add_u32 m0, s16, 4096
    s_add_u32 s60, s15, 28672
    buffer_load_dwordx4 v62, s[40:43], s60 offen lds
PFS_46:
    s_waitcnt lgkmcnt(4)
    v_mfma_f32_32x32x16_bf16 v[176:191], v[32:35], v[132:135], v[176:191]
    ds_read_b64_tr_b16 v[232:233], v215 offset:33792
    ds_read_b64_tr_b16 v[234:235], v215 offset:33920
    ds_read_b64_tr_b16 v[236:237], v215 offset:33824
    ds_read_b64_tr_b16 v[238:239], v215 offset:33952
    v_lshlrev_b32 v24, 16, v36
    v_and_b32 v25, s100, v36
    v_add_f32 v18, v18, v24
    v_add_f32 v19, v19, v25
    v_mfma_f32_32x32x16_bf16 v[192:207], v[36:39], v[132:135], v[192:207]
    v_lshlrev_b32 v26, 16, v37
    v_and_b32 v27, s100, v37
    v_add_f32 v18, v18, v26
    v_add_f32 v19, v19, v27
    s_cmp_eq_u32 s69, 0
    s_cbranch_scc1 PFS_47
    s_add_u32 m0, s16, 5120
    s_add_u32 s60, s15, 35840
    buffer_load_dwordx4 v62, s[40:43], s60 offen lds
    s_add_u32 m0, s16, 6144
    s_add_u32 s60, s15, 43008
    buffer_load_dwordx4 v62, s[40:43], s60 offen lds
    s_add_u32 m0, s16, 7168
    s_add_u32 s60, s15, 50176
    buffer_load_dwordx4 v62, s[40:43], s60 offen lds
PFS_47:
    s_waitcnt lgkmcnt(0)
    s_waitcnt vmcnt(63)
    s_barrier
    v_mfma_f32_32x32x16_bf16 v[176:191], v[40:43], v[136:139], v[176:191]
    ds_read_b64_tr_b16 v[32:33], v208 offset:0
    ds_read_b64_tr_b16 v[34:35], v208 offset:128
    ds_read_b64_tr_b16 v[36:37], v208 offset:32
    ds_read_b64_tr_b16 v[38:39], v208 offset:160
    v_lshlrev_b32 v24, 16, v42
    v_and_b32 v25, s100, v42
    v_add_f32 v16, v16, v24
    v_add_f32 v17, v17, v25
    v_mfma_f32_32x32x16_bf16 v[192:207], v[44:47], v[136:139], v[192:207]
    v_lshlrev_b32 v26, 16, v43
    v_and_b32 v27, s100, v43
    v_add_f32 v16, v16, v26
    v_add_f32 v17, v17, v27
    s_cmp_eq_u32 s69, 0
    s_cbranch_scc1 PFS_48
    s_add_u32 m0, s16, 8192
    s_add_u32 s60, s15, 57344
    buffer_load_dwordx4 v62, s[40:43], s60 offen lds
    s_add_u32 m0, s16, 9216
    s_add_u32 s60, s15, 64512
    buffer_load_dwordx4 v62, s[40:43], s60 offen lds
    s_add_u32 m0, s16, 10240
    s_add_u32 s60, s15, 71680
    buffer_load_dwordx4 v62, s[40:43], s60 offen lds
PFS_48:
    s_waitcnt lgkmcnt(4)
    v_mfma_f32_32x32x16_bf16 v[176:191], v[232:235], v[140:143], v[176:191]
    ds_read_b64_tr_b16 v[40:41], v209 offset:0
    ds_read_b64_tr_b16 v[42:43], v209 offset:128
    ds_read_b64_tr_b16 v[44:45], v209 offset:32
    ds_read_b64_tr_b16 v[46:47], v209 offset:160
    v_lshlrev_b32 v24, 16, v238
    v_and_b32 v25, s100, v238
    v_add_f32 v18, v18, v24
    v_add_f32 v19, v19, v25
    v_mfma_f32_32x32x16_bf16 v[192:207], v[236:239], v[140:143], v[192:207]
    v_lshlrev_b32 v26, 16, v239
    v_and_b32 v27, s100, v239
    v_add_f32 v18, v18, v26
    v_add_f32 v19, v19, v27
    s_cmp_eq_u32 s69, 0
    s_cbranch_scc1 PFS_49
    s_add_u32 m0, s16, 11264
    s_add_u32 s60, s15, 78848
    buffer_load_dwordx4 v62, s[40:43], s60 offen lds
    s_add_u32 m0, s16, 12288
    s_add_u32 s60, s15, 86016
    buffer_load_dwordx4 v62, s[40:43], s60 offen lds
    s_add_u32 m0, s16, 13312
    s_add_u32 s60, s15, 93184
    buffer_load_dwordx4 v62, s[40:43], s60 offen lds
PFS_49:
    s_waitcnt lgkmcnt(4)
    v_mfma_f32_32x32x16_bf16 v[176:191], v[32:35], v[144:147], v[176:191]
    ds_read_b64_tr_b16 v[232:233], v210 offset:0
    ds_read_b64_tr_b16 v[234:235], v210 offset:128
    ds_read_b64_tr_b16 v[236:237], v210 offset:32
    ds_read_b64_tr_b16 v[238:239], v210 offset:160
    v_lshlrev_b32 v24, 16, v32
    v_and_b32 v25, s100, v32
    v_add_f32 v16, v16, v24
    v_add_f32 v17, v17, v25
    v_mfma_f32_32x32x16_bf16 v[192:207], v[36:39], v[144:147], v[192:207]
    v_lshlrev_b32 v26, 16, v33
    v_and_b32 v27, s100, v33
    v_add_f32 v16, v16, v26
    v_add_f32 v17, v17, v27
    s_cmp_eq_u32 s69, 0
    s_cbranch_scc1 PFS_50
    s_add_u32 m0, s16, 14336
    s_add_u32 s60, s15, 100352
    buffer_load_dwordx4 v62, s[40:43], s60 offen lds
    s_add_u32 m0, s16, 15360
    s_add_u32 s60, s15, 107520
    buffer_load_dwordx4 v62, s[40:43], s60 offen lds
PFS_50:
    s_waitcnt lgkmcnt(4)
    v_mfma_f32_32x32x16_bf16 v[176:191], v[40:43], v[148:151], v[176:191]
    ds_read_b64_tr_b16 v[32:33], v211 offset:0
    ds_read_b64_tr_b16 v[34:35], v211 offset:128
    ds_read_b64_tr_b16 v[36:37], v211 offset:32
    ds_read_b64_tr_b16 v[38:39], v211 offset:160
    v_lshlrev_b32 v24, 16, v44
    v_and_b32 v25, s100, v44
    v_add_f32 v18, v18, v24
    v_add_f32 v19, v19, v25
    v_mfma_f32_32x32x16_bf16 v[192:207], v[44:47], v[148:151], v[192:207]
    v_lshlrev_b32 v26, 16, v45
    v_and_b32 v27, s100, v45
    v_add_f32 v18, v18, v26
    v_add_f32 v19, v19, v27
    s_waitcnt lgkmcnt(0)
    s_waitcnt vmcnt(63)
    s_barrier
    v_mfma_f32_32x32x16_bf16 v[176:191], v[232:235], v[152:155], v[176:191]
    ds_read_b64_tr_b16 v[40:41], v208 offset:33792
    ds_read_b64_tr_b16 v[42:43], v208 offset:33920
    ds_read_b64_tr_b16 v[44:45], v208 offset:33824
    ds_read_b64_tr_b16 v[46:47], v208 offset:33952
    v_lshlrev_b32 v24, 16, v234
    v_and_b32 v25, s100, v234
    v_add_f32 v16, v16, v24
    v_add_f32 v17, v17, v25
    v_mfma_f32_32x32x16_bf16 v[192:207], v[236:239], v[152:155], v[192:207]
    v_lshlrev_b32 v26, 16, v235
    v_and_b32 v27, s100, v235
    v_add_f32 v16, v16, v26
    v_add_f32 v17, v17, v27
    s_waitcnt lgkmcnt(4)
    v_mfma_f32_32x32x16_bf16 v[176:191], v[32:35], v[156:159], v[176:191]
    ds_read_b64_tr_b16 v[232:233], v209 offset:33792
    ds_read_b64_tr_b16 v[234:235], v209 offset:33920
    ds_read_b64_tr_b16 v[236:237], v209 offset:33824
    ds_read_b64_tr_b16 v[238:239], v209 offset:33952
    v_lshlrev_b32 v24, 16, v38
    v_and_b32 v25, s100, v38
    v_add_f32 v18, v18, v24
    v_add_f32 v19, v19, v25
    v_mfma_f32_32x32x16_bf16 v[192:207], v[36:39], v[156:159], v[192:207]
    v_lshlrev_b32 v26, 16, v39
    v_and_b32 v27, s100, v39
    v_add_f32 v18, v18, v26
    v_add_f32 v19, v19, v27
    buffer_load_dword v3, v2, s[36:39], s10 offen sc1
    s_waitcnt lgkmcnt(4)
    v_mfma_f32_32x32x16_bf16 v[176:191], v[40:43], v[160:163], v[176:191]
    ds_read_b64_tr_b16 v[32:33], v210 offset:33792
    ds_read_b64_tr_b16 v[34:35], v210 offset:33920
    ds_read_b64_tr_b16 v[36:37], v210 offset:33824
    ds_read_b64_tr_b16 v[38:39], v210 offset:33952
    v_lshlrev_b32 v24, 16, v40
    v_and_b32 v25, s100, v40
    v_add_f32 v16, v16, v24
    v_add_f32 v17, v17, v25
    v_mfma_f32_32x32x16_bf16 v[192:207], v[44:47], v[160:163], v[192:207]
    v_lshlrev_b32 v26, 16, v41
    v_and_b32 v27, s100, v41
    v_add_f32 v16, v16, v26
    v_add_f32 v17, v17, v27
    s_waitcnt lgkmcnt(4)
    v_mfma_f32_32x32x16_bf16 v[176:191], v[232:235], v[164:167], v[176:191]
    ds_read_b64_tr_b16 v[40:41], v211 offset:33792
    ds_read_b64_tr_b16 v[42:43], v211 offset:33920
    ds_read_b64_tr_b16 v[44:45], v211 offset:33824
    ds_read_b64_tr_b16 v[46:47], v211 offset:33952
    v_lshlrev_b32 v24, 16, v236
    v_and_b32 v25, s100, v236
    v_add_f32 v18, v18, v24
    v_add_f32 v19, v19, v25
    v_mfma_f32_32x32x16_bf16 v[192:207], v[236:239], v[164:167], v[192:207]
    v_lshlrev_b32 v26, 16, v237
    v_and_b32 v27, s100, v237
    v_add_f32 v18, v18, v26
    v_add_f32 v19, v19, v27
    s_waitcnt lgkmcnt(0)
    v_mfma_f32_32x32x16_bf16 v[176:191], v[32:35], v[168:171], v[176:191]
    v_lshlrev_b32 v24, 16, v34
    v_and_b32 v25, s100, v34
    v_add_f32 v16, v16, v24
    v_add_f32 v17, v17, v25
    v_mfma_f32_32x32x16_bf16 v[192:207], v[36:39], v[168:171], v[192:207]
    v_lshlrev_b32 v26, 16, v35
    v_and_b32 v27, s100, v35
    v_add_f32 v16, v16, v26
    v_add_f32 v17, v17, v27
    s_waitcnt lgkmcnt(0)
    v_mfma_f32_32x32x16_bf16 v[176:191], v[40:43], v[172:175], v[176:191]
    v_lshlrev_b32 v24, 16, v46
    v_and_b32 v25, s100, v46
    v_add_f32 v18, v18, v24
    v_add_f32 v19, v19, v25
    v_mfma_f32_32x32x16_bf16 v[192:207], v[44:47], v[172:175], v[192:207]
    v_lshlrev_b32 v26, 16, v47
    v_and_b32 v27, s100, v47
    v_add_f32 v18, v18, v26
    v_add_f32 v19, v19, v27
    s_waitcnt vmcnt(0)
    v_cmp_ne_u32 vcc, s57, v3
    s_nop 1
    s_cmp_eq_u64 vcc, 0
    s_cselect_b32 s12, 1, 0
    s_lshl_b32 s60, s69, 5
    s_add_u32 s60, s60, s59
    s_cmp_ge_u32 s60, 60
    s_cselect_b32 s12, 2, s12
    s_cmp_eq_u32 s69, 0
    s_cselect_b32 s23, 8, 0
    s_cmp_eq_u32 s12, 1
    s_cselect_b32 s23, s23, 0
    s_cmp_le_u32 s23, 0
    s_cbranch_scc1 ESK_51
    buffer_load_dwordx4 v[64:67], v63, s[36:39], s8 offen sc1
    buffer_load_dwordx4 v[68:71], v63, s[36:39], s9 offen sc1
    s_add_u32 s8, s8, 1024
    s_add_u32 s31, s31, 1024
    s_and_b32 s31, s31, s5
    s_add_u32 s9, s30, s31
    buffer_load_dwordx4 v[72:75], v63, s[36:39], s8 offen sc1
    buffer_load_dwordx4 v[76:79], v63, s[36:39], s9 offen sc1
    s_add_u32 s8, s8, 1024
    s_add_u32 s31, s31, 1024
    s_and_b32 s31, s31, s5
    s_add_u32 s9, s30, s31
ESK_51:
    s_cmp_le_u32 s23, 2
    s_cbranch_scc1 ESK_52
    buffer_load_dwordx4 v[80:83], v63, s[36:39], s8 offen sc1
    buffer_load_dwordx4 v[84:87], v63, s[36:39], s9 offen sc1
    s_add_u32 s8, s8, 1024
    s_add_u32 s31, s31, 1024
    s_and_b32 s31, s31, s5
    s_add_u32 s9, s30, s31
    buffer_load_dwordx4 v[88:91], v63, s[36:39], s8 offen sc1
    buffer_load_dwordx4 v[92:95], v63, s[36:39], s9 offen sc1
    s_add_u32 s8, s8, 1024
    s_add_u32 s31, s31, 1024
    s_and_b32 s31, s31, s5
    s_add_u32 s9, s30, s31
ESK_52:
    s_cmp_le_u32 s23, 4
    s_cbranch_scc1 ESK_53
    buffer_load_dwordx4 v[96:99], v63, s[36:39], s8 offen sc1
    buffer_load_dwordx4 v[100:103], v63, s[36:39], s9 offen sc1
    s_add_u32 s8, s8, 1024
    s_add_u32 s31, s31, 1024
    s_and_b32 s31, s31, s5
    s_add_u32 s9, s30, s31
    buffer_load_dwordx4 v[104:107], v63, s[36:39], s8 offen sc1
    buffer_load_dwordx4 v[108:111], v63, s[36:39], s9 offen sc1
    s_add_u32 s8, s8, 1024
    s_add_u32 s31, s31, 1024
    s_and_b32 s31, s31, s5
    s_add_u32 s9, s30, s31
ESK_53:
    s_cmp_le_u32 s23, 6
    s_cbranch_scc1 ESK_54
    buffer_load_dwordx4 v[112:115], v63, s[36:39], s8 offen sc1
    buffer_load_dwordx4 v[116:119], v63, s[36:39], s9 offen sc1
    s_add_u32 s8, s8, 1024
    s_add_u32 s31, s31, 1024
    s_and_b32 s31, s31, s5
    s_add_u32 s9, s30, s31
    buffer_load_dwordx4 v[120:123], v63, s[36:39], s8 offen sc1
    buffer_load_dwordx4 v[124:127], v63, s[36:39], s9 offen sc1
    s_add_u32 s8, s8, 1024
    s_mov_b32 s9, s11
ESK_54:
    v_lshlrev_b32 v5, 4, v1
    s_lshl_b32 s60, s69, 11
    s_add_u32 s60, s60, 135168
    v_add_u32 v7, s60, v5
    s_lshl_b32 s60, s68, 2
    v_add_u32 v6, s60, v7
    v_add_f32 v16, v16, v17
    v_add_f32 v18, v18, v19
    ds_write_b32 v6, v16
    ds_write_b32 v6, v18 offset:1024
    s_waitcnt lgkmcnt(0)
    s_barrier
    ds_read_b128 v[8:11], v7
    ds_read_b128 v[12:15], v7 offset:1024
    v_mov_b32 v16, 0
    v_mov_b32 v17, 0
    v_mov_b32 v18, 0
    v_mov_b32 v19, 0
    s_waitcnt lgkmcnt(1)
    v_add_f32 v8, v8, v9
    v_add_f32 v10, v10, v11
    v_add_f32 v8, v8, v10
    v_cvt_pk_bf16_f32 v24, v8, v8
    v_and_b32 v9, 0xffff0000, v24
    v_sub_f32 v8, v8, v9
    v_cvt_pk_bf16_f32 v25, v8, v8
    v_mov_b32 v26, 0
    v_mov_b32 v27, 0
    s_nop 1
    v_mfma_f32_32x32x16_bf16 v[176:191], v[24:27], v[58:61], v[176:191]
    s_waitcnt lgkmcnt(0)
    v_add_f32 v12, v12, v13
    v_add_f32 v14, v14, v15
    v_add_f32 v12, v12, v14
    v_cvt_pk_bf16_f32 v28, v12, v12
    v_and_b32 v13, 0xffff0000, v28
    v_sub_f32 v12, v12, v13
    v_cvt_pk_bf16_f32 v29, v12, v12
    v_mov_b32 v30, 0
    v_mov_b32 v31, 0
    s_nop 1
    v_mfma_f32_32x32x16_bf16 v[192:207], v[28:31], v[58:61], v[192:207]
    s_lshl_b32 s60, s66, 2
    s_add_u32 s60, s60, s68
    s_add_u32 s63, s67, 12
    s_mul_i32 s61, s60, 114688
    s_lshl_b32 s62, s63, 12
    s_add_u32 s61, s61, s62
    s_lshl_b32 s62, s69, 11
    s_add_u32 s61, s61, s62
    s_nop 4
    v_max_f32 v176, 0, v176
    v_max_f32 v177, 0, v177
    v_max_f32 v178, 0, v178
    v_max_f32 v179, 0, v179
    v_max_f32 v180, 0, v180
    v_max_f32 v181, 0, v181
    v_max_f32 v182, 0, v182
    v_max_f32 v183, 0, v183
    v_mul_f32 v176, v176, v184
    v_mul_f32 v177, v177, v185
    v_mul_f32 v178, v178, v186
    v_mul_f32 v179, v179, v187
    v_mul_f32 v180, v180, v188
    v_mul_f32 v181, v181, v189
    v_mul_f32 v182, v182, v190
    v_mul_f32 v183, v183, v191
    v_cvt_pk_bf16_f32 v8, v176, v177
    v_cvt_pk_bf16_f32 v9, v178, v179
    v_cvt_pk_bf16_f32 v10, v180, v181
    v_cvt_pk_bf16_f32 v11, v182, v183
    buffer_store_dwordx4 v[8:11], v5, s[36:39], s61 offen offset:0 sc1
    v_max_f32 v192, 0, v192
    v_max_f32 v193, 0, v193
    v_max_f32 v194, 0, v194
    v_max_f32 v195, 0, v195
    v_max_f32 v196, 0, v196
    v_max_f32 v197, 0, v197
    v_max_f32 v198, 0, v198
    v_max_f32 v199, 0, v199
    v_mul_f32 v192, v192, v200
    v_mul_f32 v193, v193, v201
    v_mul_f32 v194, v194, v202
    v_mul_f32 v195, v195, v203
    v_mul_f32 v196, v196, v204
    v_mul_f32 v197, v197, v205
    v_mul_f32 v198, v198, v206
    v_mul_f32 v199, v199, v207
    v_cvt_pk_bf16_f32 v12, v192, v193
    v_cvt_pk_bf16_f32 v13, v194, v195
    v_cvt_pk_bf16_f32 v14, v196, v197
    v_cvt_pk_bf16_f32 v15, v198, v199
    buffer_store_dwordx4 v[12:15], v5, s[36:39], s61 offen offset:1024 sc1
    s_lshl_b32 s60, s66, 6
    s_lshl_b32 s61, s67, 2
    s_add_u32 s60, s60, s61
    s_add_u32 s6, s60, 11805696
    s_cmp_eq_u32 s12, 2
    s_cbranch_scc1 L_LOADED
    s_cmp_eq_u32 s69, 0
    s_cbranch_scc1 L_NOPF2
L_NOPF2:
    s_cmp_lg_u32 s12, 0
    s_cbranch_scc1 L_RDY
    s_mov_b32 s62, 0
POLL_55:
    buffer_load_dword v3, v2, s[36:39], s10 offen sc1
    s_waitcnt vmcnt(0)
    v_cmp_ne_u32 vcc, s57, v3
    s_add_u32 s62, s62, 1
    s_cbranch_vccz POLLD_56
    s_sleep 1
    s_cmp_lt_u32 s62, 0x100000
    s_cbranch_scc1 POLL_55
POLLD_56:
L_RDY:
    s_cmp_gt_u32 s23, 0
    s_cbranch_scc1 LSK_57
    buffer_load_dwordx4 v[64:67], v63, s[36:39], s8 offen sc1
    buffer_load_dwordx4 v[68:71], v63, s[36:39], s9 offen sc1
    s_add_u32 s8, s8, 1024
    s_add_u32 s31, s31, 1024
    s_and_b32 s31, s31, s5
    s_add_u32 s9, s30, s31
    buffer_load_dwordx4 v[72:75], v63, s[36:39], s8 offen sc1
    buffer_load_dwordx4 v[76:79], v63, s[36:39], s9 offen sc1
    s_add_u32 s8, s8, 1024
    s_add_u32 s31, s31, 1024
    s_and_b32 s31, s31, s5
    s_add_u32 s9, s30, s31
LSK_57:
    s_cmp_gt_u32 s23, 2
    s_cbranch_scc1 LSK_58
    buffer_load_dwordx4 v[80:83], v63, s[36:39], s8 offen sc1
    buffer_load_dwordx4 v[84:87], v63, s[36:39], s9 offen sc1
    s_add_u32 s8, s8, 1024
    s_add_u32 s31, s31, 1024
    s_and_b32 s31, s31, s5
    s_add_u32 s9, s30, s31
    buffer_load_dwordx4 v[88:91], v63, s[36:39], s8 offen sc1
    buffer_load_dwordx4 v[92:95], v63, s[36:39], s9 offen sc1
    s_add_u32 s8, s8, 1024
    s_add_u32 s31, s31, 1024
    s_and_b32 s31, s31, s5
    s_add_u32 s9, s30, s31
LSK_58:
    s_cmp_lg_u32 s69, 0
    s_cbranch_scc1 L_LOADED
    s_cmp_gt_u32 s23, 4
    s_cbranch_scc1 LSK_59
    buffer_load_dwordx4 v[96:99], v63, s[36:39], s8 offen sc1
    buffer_load_dwordx4 v[100:103], v63, s[36:39], s9 offen sc1
    s_add_u32 s8, s8, 1024
    s_add_u32 s31, s31, 1024
    s_and_b32 s31, s31, s5
    s_add_u32 s9, s30, s31
    buffer_load_dwordx4 v[104:107], v63, s[36:39], s8 offen sc1
    buffer_load_dwordx4 v[108:111], v63, s[36:39], s9 offen sc1
    s_add_u32 s8, s8, 1024
    s_add_u32 s31, s31, 1024
    s_and_b32 s31, s31, s5
    s_add_u32 s9, s30, s31
LSK_59:
    s_cmp_gt_u32 s23, 6
    s_cbranch_scc1 LSK_60
    buffer_load_dwordx4 v[112:115], v63, s[36:39], s8 offen sc1
    buffer_load_dwordx4 v[116:119], v63, s[36:39], s9 offen sc1
    s_add_u32 s8, s8, 1024
    s_add_u32 s31, s31, 1024
    s_and_b32 s31, s31, s5
    s_add_u32 s9, s30, s31
    buffer_load_dwordx4 v[120:123], v63, s[36:39], s8 offen sc1
    buffer_load_dwordx4 v[124:127], v63, s[36:39], s9 offen sc1
    s_add_u32 s8, s8, 1024
    s_mov_b32 s9, s11
LSK_60:
    s_cmp_gt_u32 s23, 8
    s_cbranch_scc1 LSK_61
    buffer_load_dwordx4 v[128:131], v63, s[36:39], s8 offen sc1
    buffer_load_dwordx4 v[132:135], v63, s[36:39], s9 offen sc1
    s_add_u32 s8, s8, 1024
    s_add_u32 s9, s9, 1024
    buffer_load_dwordx4 v[136:139], v63, s[36:39], s8 offen sc1
    buffer_load_dwordx4 v[140:143], v63, s[36:39], s9 offen sc1
    s_add_u32 s8, s8, 1024
    s_add_u32 s9, s9, 1024
LSK_61:
    s_cmp_gt_u32 s23, 10
    s_cbranch_scc1 LSK_62
    buffer_load_dwordx4 v[144:147], v63, s[36:39], s8 offen sc1
    buffer_load_dwordx4 v[148:151], v63, s[36:39], s9 offen sc1
    s_add_u32 s8, s8, 1024
    s_add_u32 s9, s9, 1024
    buffer_load_dwordx4 v[152:155], v63, s[36:39], s8 offen sc1
    buffer_load_dwordx4 v[156:159], v63, s[36:39], s9 offen sc1
    s_add_u32 s8, s8, 1024
    s_add_u32 s9, s9, 1024
LSK_62:
L_LOADED:
    s_cmp_ge_u32 s56, 4
    s_cbranch_scc1 L_G
    v_lshlrev_b32 v2, 4, v1
    v_lshlrev_b32 v4, 2, v1
    v_add_u32 v4, 147456, v4
    s_lshl_b32 s60, s56, 8
    v_add_u32 v5, s60, v4
    v_mov_b32 v6, 151560
    s_waitcnt vmcnt(20)
    v_mfma_f32_32x32x16_bf16 v[24:39], v[64:67], v[68:71], 0
    v_mfma_f32_32x32x16_bf16 v[24:39], v[72:75], v[76:79], v[24:39]
    v_mov_b32 v160, 0
    v_mov_b32 v161, 0
    v_mov_b32 v162, 0
    v_mov_b32 v163, 0
    v_mov_b32 v164, 0
    v_mov_b32 v165, 0
    v_mov_b32 v166, 0
    v_mov_b32 v167, 0
    v_mov_b32 v168, 0
    v_mov_b32 v169, 0
    v_mov_b32 v170, 0
    v_mov_b32 v171, 0
    v_mov_b32 v172, 0
    v_mov_b32 v173, 0
    v_mov_b32 v174, 0
    v_mov_b32 v175, 0
    v_mov_b32 v176, 0
    v_mov_b32 v177, 0
    v_mov_b32 v178, 0
    v_mov_b32 v179, 0
    v_max3_f32 v52, v24, v25, v26
    v_max3_f32 v52, v52, v27, v28
    v_max3_f32 v52, v52, v29, v30
    v_max3_f32 v52, v52, v31, v32
    v_max3_f32 v52, v52, v33, v34
    v_max3_f32 v52, v52, v35, v36
    v_max3_f32 v52, v52, v37, v38
    v_max_f32 v52, v52, v39
    v_mov_b32 v53, v52
    s_nop 1
    v_permlane32_swap_b32 v52, v53
    v_max_f32 v52, v52, v53
    v_sub_f32 v52, 0xc2b40000, v52
    v_cvt_pk_bf16_f32 v52, v52, v52
    v_lshrrev_b32 v52, 16, v52
    ds_write_b32 v5, v52
    s_waitcnt lgkmcnt(0)
    s_mov_b64 exec, 1
    v_mov_b32 v7, 1
    ds_add_u32 v6, v7
    s_mov_b64 exec, -1
    v_mov_b32 v180, 0
    v_mov_b32 v181, 0
    v_mov_b32 v182, 0
    v_mov_b32 v183, 0
    v_mov_b32 v184, 0
    v_mov_b32 v185, 0
    v_mov_b32 v186, 0
    v_mov_b32 v187, 0
    v_mov_b32 v188, 0
    v_mov_b32 v189, 0
    v_mov_b32 v190, 0
    v_mov_b32 v191, 0
    v_mov_b32 v192, 0
    v_mov_b32 v193, 0
    v_mov_b32 v194, 0
    v_mov_b32 v195, 0
    v_mov_b32 v196, 0
    v_mov_b32 v197, 0
    v_mov_b32 v198, 0
    v_mov_b32 v199, 0
    v_mov_b32 v200, 0
    v_mov_b32 v201, 0
    v_mov_b32 v202, 0
    v_mov_b32 v203, 0
    v_mov_b32 v204, 0
    v_mov_b32 v205, 0
    v_mov_b32 v206, 0
    v_mov_b32 v207, 0
    v_mov_b32 v208, 0
    v_mov_b32 v209, 0
    v_mov_b32 v210, 0
    v_mov_b32 v211, 0
    v_mov_b32 v212, 0
    v_mov_b32 v213, 0
    v_mov_b32 v214, 0
    v_mov_b32 v215, 0
    v_mov_b32 v216, 0
    v_mov_b32 v217, 0
    v_mov_b32 v218, 0
    v_mov_b32 v219, 0
    v_mov_b32 v220, 0
    v_mov_b32 v221, 0
    v_mov_b32 v222, 0
    v_mov_b32 v223, 0
    v_mov_b32 v44, 0
    v_mov_b32 v45, 0
    v_mov_b32 v46, 0
    v_mov_b32 v47, 0
    s_add_u32 s60, s56, 1
    s_and_b32 s60, s60, 3
    s_lshl_b32 s60, s60, 8
    v_add_u32 v49, s60, v4
    s_add_u32 s60, s56, 2
    s_and_b32 s60, s60, 3
    s_lshl_b32 s60, s60, 8
    v_add_u32 v50, s60, v4
    s_add_u32 s60, s56, 3
    s_and_b32 s60, s60, 3
    s_lshl_b32 s60, s60, 8
    v_add_u32 v51, s60, v4
    s_mov_b32 s62, 0
MS_63:
    ds_read_b32 v7, v6
    s_waitcnt lgkmcnt(0)
    v_cmp_gt_u32 vcc, 4, v7
    s_add_u32 s62, s62, 1
    s_cbranch_vccz MSD_64
    s_cmp_lt_u32 s62, 0x1000000
    s_cbranch_scc1 MS_63
MSD_64:
    s_waitcnt vmcnt(8)
    s_mov_b32 exec_lo, 0
    v_mov_b32 v76, v52
    ds_read_b32 v92, v49
    ds_read_b32 v108, v50
    ds_read_b32 v124, v51
    s_mov_b64 exec, -1
    v_mfma_f32_32x32x16_bf16 v[8:23], v[64:67], v[68:71], 0
    v_mfma_f32_32x32x16_bf16 v[8:23], v[72:75], v[76:79], v[8:23]
    s_mov_b64 exec, 1
    v_mov_b32 v52, 151552
    v_mov_b32 v53, 1
    ds_add_rtn_u32 v53, v52, v53
    s_waitcnt lgkmcnt(0)
    v_readfirstlane_b32 s60, v53
    s_cmp_lg_u32 s60, 7
    s_cbranch_scc1 PB_65
    v_mov_b32 v52, 0
    v_mov_b32 v53, s57
    buffer_store_dword v53, v52, s[36:39], s6 offen sc1
PB_65:
    s_mov_b64 exec, -1
    s_mov_b32 s69, 0
L_ALOOP:
    v_exp_f32 v8, v8
    v_exp_f32 v9, v9
    v_mfma_f32_32x32x16_bf16 v[208:223], v[156:159], v[44:47], v[208:223]
    buffer_load_dwordx4 v[148:151], v63, s[36:39], s21 offen offset:2048 sc1
    buffer_load_dwordx4 v[156:159], v63, s[36:39], s21 offen offset:3072 sc1
    s_add_u32 s19, s19, 4096
    s_and_b32 s19, s19, 0xffff
    s_add_u32 s21, s20, s19
    v_exp_f32 v10, v10
    v_exp_f32 v11, v11
    v_cvt_pk_bf16_f32 v40, v8, v9
    v_cvt_pk_bf16_f32 v41, v10, v11
    v_exp_f32 v12, v12
    v_exp_f32 v13, v13
    v_mfma_f32_32x32x16_bf16 v[24:39], v[64:67], v[84:87], 0
    v_exp_f32 v14, v14
    v_exp_f32 v15, v15
    v_cvt_pk_bf16_f32 v42, v12, v13
    v_cvt_pk_bf16_f32 v43, v14, v15
    v_mfma_f32_32x32x16_bf16 v[24:39], v[72:75], v[92:95], v[24:39]
    v_exp_f32 v16, v16
    v_exp_f32 v17, v17
    v_exp_f32 v18, v18
    v_exp_f32 v19, v19
    v_cvt_pk_bf16_f32 v44, v16, v17
    v_cvt_pk_bf16_f32 v45, v18, v19
    v_exp_f32 v20, v20
    v_exp_f32 v21, v21
    s_waitcnt vmcnt(12)
    v_mfma_f32_32x32x16_bf16 v[160:175], v[80:83], v[40:43], v[160:175]
    v_exp_f32 v22, v22
    v_exp_f32 v23, v23
    v_cvt_pk_bf16_f32 v46, v20, v21
    v_cvt_pk_bf16_f32 v47, v22, v23
    v_exp_f32 v24, v24
    v_exp_f32 v25, v25
    v_mfma_f32_32x32x16_bf16 v[160:175], v[88:91], v[44:47], v[160:175]
    v_exp_f32 v26, v26
    v_exp_f32 v27, v27
    v_cvt_pk_bf16_f32 v40, v24, v25
    v_cvt_pk_bf16_f32 v41, v26, v27
    v_exp_f32 v28, v28
    v_exp_f32 v29, v29
    v_mfma_f32_32x32x16_bf16 v[8:23], v[64:67], v[100:103], 0
    v_exp_f32 v30, v30
    v_exp_f32 v31, v31
    v_cvt_pk_bf16_f32 v42, v28, v29
    v_cvt_pk_bf16_f32 v43, v30, v31
    v_mfma_f32_32x32x16_bf16 v[8:23], v[72:75], v[108:111], v[8:23]
    v_exp_f32 v32, v32
    v_exp_f32 v33, v33
    v_exp_f32 v34, v34
    v_exp_f32 v35, v35
    v_cvt_pk_bf16_f32 v44, v32, v33
    v_cvt_pk_bf16_f32 v45, v34, v35
    v_exp_f32 v36, v36
    v_exp_f32 v37, v37
    v_mfma_f32_32x32x16_bf16 v[176:191], v[80:83], v[40:43], v[176:191]
    v_exp_f32 v38, v38
    v_exp_f32 v39, v39
    v_cvt_pk_bf16_f32 v46, v36, v37
    v_cvt_pk_bf16_f32 v47, v38, v39
    v_exp_f32 v8, v8
    v_exp_f32 v9, v9
    v_mfma_f32_32x32x16_bf16 v[176:191], v[88:91], v[44:47], v[176:191]
    v_exp_f32 v10, v10
    v_exp_f32 v11, v11
    v_cvt_pk_bf16_f32 v40, v8, v9
    v_cvt_pk_bf16_f32 v41, v10, v11
    v_exp_f32 v12, v12
    v_exp_f32 v13, v13
    v_mfma_f32_32x32x16_bf16 v[24:39], v[64:67], v[116:119], 0
    v_exp_f32 v14, v14
    v_exp_f32 v15, v15
    v_cvt_pk_bf16_f32 v42, v12, v13
    v_cvt_pk_bf16_f32 v43, v14, v15
    v_mfma_f32_32x32x16_bf16 v[24:39], v[72:75], v[124:127], v[24:39]
    buffer_load_dwordx4 v[64:67], v63, s[36:39], s21 offen offset:0 sc1
    buffer_load_dwordx4 v[72:75], v63, s[36:39], s21 offen offset:1024 sc1
    v_exp_f32 v16, v16
    v_exp_f32 v17, v17
    v_exp_f32 v18, v18
    v_exp_f32 v19, v19
    v_cvt_pk_bf16_f32 v44, v16, v17
    v_cvt_pk_bf16_f32 v45, v18, v19
    v_exp_f32 v20, v20
    v_exp_f32 v21, v21
    v_mfma_f32_32x32x16_bf16 v[192:207], v[80:83], v[40:43], v[192:207]
    v_exp_f32 v22, v22
    v_exp_f32 v23, v23
    v_cvt_pk_bf16_f32 v46, v20, v21
    v_cvt_pk_bf16_f32 v47, v22, v23
    v_exp_f32 v24, v24
    v_exp_f32 v25, v25
    v_mfma_f32_32x32x16_bf16 v[192:207], v[88:91], v[44:47], v[192:207]
    v_exp_f32 v26, v26
    v_exp_f32 v27, v27
    v_cvt_pk_bf16_f32 v40, v24, v25
    v_cvt_pk_bf16_f32 v41, v26, v27
    v_exp_f32 v28, v28
    v_exp_f32 v29, v29
    s_waitcnt vmcnt(12)
    v_mfma_f32_32x32x16_bf16 v[8:23], v[96:99], v[68:71], 0
    v_exp_f32 v30, v30
    v_exp_f32 v31, v31
    v_cvt_pk_bf16_f32 v42, v28, v29
    v_cvt_pk_bf16_f32 v43, v30, v31
    v_mfma_f32_32x32x16_bf16 v[8:23], v[104:107], v[76:79], v[8:23]
    v_exp_f32 v32, v32
    v_exp_f32 v33, v33
    v_exp_f32 v34, v34
    v_exp_f32 v35, v35
    v_cvt_pk_bf16_f32 v44, v32, v33
    v_cvt_pk_bf16_f32 v45, v34, v35
    v_exp_f32 v36, v36
    v_exp_f32 v37, v37
    v_mfma_f32_32x32x16_bf16 v[208:223], v[80:83], v[40:43], v[208:223]
    v_exp_f32 v38, v38
    v_exp_f32 v39, v39
    v_cvt_pk_bf16_f32 v46, v36, v37
    v_cvt_pk_bf16_f32 v47, v38, v39
    v_exp_f32 v8, v8
    v_exp_f32 v9, v9
    v_mfma_f32_32x32x16_bf16 v[208:223], v[88:91], v[44:47], v[208:223]
    buffer_load_dwordx4 v[80:83], v63, s[36:39], s21 offen offset:2048 sc1
    buffer_load_dwordx4 v[88:91], v63, s[36:39], s21 offen offset:3072 sc1
    s_add_u32 s19, s19, 4096
    s_and_b32 s19, s19, 0xffff
    s_add_u32 s21, s20, s19
    v_exp_f32 v10, v10
    v_exp_f32 v11, v11
    v_cvt_pk_bf16_f32 v40, v8, v9
    v_cvt_pk_bf16_f32 v41, v10, v11
    v_exp_f32 v12, v12
    v_exp_f32 v13, v13
    v_mfma_f32_32x32x16_bf16 v[24:39], v[96:99], v[84:87], 0
    v_exp_f32 v14, v14
    v_exp_f32 v15, v15
    v_cvt_pk_bf16_f32 v42, v12, v13
    v_cvt_pk_bf16_f32 v43, v14, v15
    v_mfma_f32_32x32x16_bf16 v[24:39], v[104:107], v[92:95], v[24:39]
    v_exp_f32 v16, v16
    v_exp_f32 v17, v17
    v_exp_f32 v18, v18
    v_exp_f32 v19, v19
    v_cvt_pk_bf16_f32 v44, v16, v17
    v_cvt_pk_bf16_f32 v45, v18, v19
    v_exp_f32 v20, v20
    v_exp_f32 v21, v21
    s_waitcnt vmcnt(12)
    v_mfma_f32_32x32x16_bf16 v[160:175], v[112:115], v[40:43], v[160:175]
    v_exp_f32 v22, v22
    v_exp_f32 v23, v23
    v_cvt_pk_bf16_f32 v46, v20, v21
    v_cvt_pk_bf16_f32 v47, v22, v23
    v_exp_f32 v24, v24
    v_exp_f32 v25, v25
    v_mfma_f32_32x32x16_bf16 v[160:175], v[120:123], v[44:47], v[160:175]
    v_exp_f32 v26, v26
    v_exp_f32 v27, v27
    v_cvt_pk_bf16_f32 v40, v24, v25
    v_cvt_pk_bf16_f32 v41, v26, v27
    v_exp_f32 v28, v28
    v_exp_f32 v29, v29
    v_mfma_f32_32x32x16_bf16 v[8:23], v[96:99], v[100:103], 0
    v_exp_f32 v30, v30
    v_exp_f32 v31, v31
    v_cvt_pk_bf16_f32 v42, v28, v29
    v_cvt_pk_bf16_f32 v43, v30, v31
    v_mfma_f32_32x32x16_bf16 v[8:23], v[104:107], v[108:111], v[8:23]
    v_exp_f32 v32, v32
    v_exp_f32 v33, v33
    v_exp_f32 v34, v34
    v_exp_f32 v35, v35
    v_cvt_pk_bf16_f32 v44, v32, v33
    v_cvt_pk_bf16_f32 v45, v34, v35
    v_exp_f32 v36, v36
    v_exp_f32 v37, v37
    v_mfma_f32_32x32x16_bf16 v[176:191], v[112:115], v[40:43], v[176:191]
    v_exp_f32 v38, v38
    v_exp_f32 v39, v39
    v_cvt_pk_bf16_f32 v46, v36, v37
    v_cvt_pk_bf16_f32 v47, v38, v39
    v_exp_f32 v8, v8
    v_exp_f32 v9, v9
    v_mfma_f32_32x32x16_bf16 v[176:191], v[120:123], v[44:47], v[176:191]
    v_exp_f32 v10, v10
    v_exp_f32 v11, v11
    v_cvt_pk_bf16_f32 v40, v8, v9
    v_cvt_pk_bf16_f32 v41, v10, v11
    v_exp_f32 v12, v12
    v_exp_f32 v13, v13
    v_mfma_f32_32x32x16_bf16 v[24:39], v[96:99], v[116:119], 0
    v_exp_f32 v14, v14
    v_exp_f32 v15, v15
    v_cvt_pk_bf16_f32 v42, v12, v13
    v_cvt_pk_bf16_f32 v43, v14, v15
    v_mfma_f32_32x32x16_bf16 v[24:39], v[104:107], v[124:127], v[24:39]
    buffer_load_dwordx4 v[96:99], v63, s[36:39], s21 offen offset:0 sc1
    buffer_load_dwordx4 v[104:107], v63, s[36:39], s21 offen offset:1024 sc1
    v_exp_f32 v16, v16
    v_exp_f32 v17, v17
    v_exp_f32 v18, v18
    v_exp_f32 v19, v19
    v_cvt_pk_bf16_f32 v44, v16, v17
    v_cvt_pk_bf16_f32 v45, v18, v19
    v_exp_f32 v20, v20
    v_exp_f32 v21, v21
    v_mfma_f32_32x32x16_bf16 v[192:207], v[112:115], v[40:43], v[192:207]
    v_exp_f32 v22, v22
    v_exp_f32 v23, v23
    v_cvt_pk_bf16_f32 v46, v20, v21
    v_cvt_pk_bf16_f32 v47, v22, v23
    v_exp_f32 v24, v24
    v_exp_f32 v25, v25
    v_mfma_f32_32x32x16_bf16 v[192:207], v[120:123], v[44:47], v[192:207]
    v_exp_f32 v26, v26
    v_exp_f32 v27, v27
    v_cvt_pk_bf16_f32 v40, v24, v25
    v_cvt_pk_bf16_f32 v41, v26, v27
    v_exp_f32 v28, v28
    v_exp_f32 v29, v29
    s_waitcnt vmcnt(12)
    v_mfma_f32_32x32x16_bf16 v[8:23], v[128:131], v[68:71], 0
    v_exp_f32 v30, v30
    v_exp_f32 v31, v31
    v_cvt_pk_bf16_f32 v42, v28, v29
    v_cvt_pk_bf16_f32 v43, v30, v31
    v_mfma_f32_32x32x16_bf16 v[8:23], v[136:139], v[76:79], v[8:23]
    v_exp_f32 v32, v32
    v_exp_f32 v33, v33
    v_exp_f32 v34, v34
    v_exp_f32 v35, v35
    v_cvt_pk_bf16_f32 v44, v32, v33
    v_cvt_pk_bf16_f32 v45, v34, v35
    v_exp_f32 v36, v36
    v_exp_f32 v37, v37
    v_mfma_f32_32x32x16_bf16 v[208:223], v[112:115], v[40:43], v[208:223]
    v_exp_f32 v38, v38
    v_exp_f32 v39, v39
    v_cvt_pk_bf16_f32 v46, v36, v37
    v_cvt_pk_bf16_f32 v47, v38, v39
    v_exp_f32 v8, v8
    v_exp_f32 v9, v9
    v_mfma_f32_32x32x16_bf16 v[208:223], v[120:123], v[44:47], v[208:223]
    buffer_load_dwordx4 v[112:115], v63, s[36:39], s21 offen offset:2048 sc1
    buffer_load_dwordx4 v[120:123], v63, s[36:39], s21 offen offset:3072 sc1
    s_add_u32 s19, s19, 4096
    s_and_b32 s19, s19, 0xffff
    s_add_u32 s21, s20, s19
    v_exp_f32 v10, v10
    v_exp_f32 v11, v11
    v_cvt_pk_bf16_f32 v40, v8, v9
    v_cvt_pk_bf16_f32 v41, v10, v11
    v_exp_f32 v12, v12
    v_exp_f32 v13, v13
    v_mfma_f32_32x32x16_bf16 v[24:39], v[128:131], v[84:87], 0
    v_exp_f32 v14, v14
    v_exp_f32 v15, v15
    v_cvt_pk_bf16_f32 v42, v12, v13
    v_cvt_pk_bf16_f32 v43, v14, v15
    v_mfma_f32_32x32x16_bf16 v[24:39], v[136:139], v[92:95], v[24:39]
    v_exp_f32 v16, v16
    v_exp_f32 v17, v17
    v_exp_f32 v18, v18
    v_exp_f32 v19, v19
    v_cvt_pk_bf16_f32 v44, v16, v17
    v_cvt_pk_bf16_f32 v45, v18, v19
    v_exp_f32 v20, v20
    v_exp_f32 v21, v21
    s_waitcnt vmcnt(10)
    v_mfma_f32_32x32x16_bf16 v[160:175], v[144:147], v[40:43], v[160:175]
    v_exp_f32 v22, v22
    v_exp_f32 v23, v23
    v_cvt_pk_bf16_f32 v46, v20, v21
    v_cvt_pk_bf16_f32 v47, v22, v23
    v_exp_f32 v24, v24
    v_exp_f32 v25, v25
    v_mfma_f32_32x32x16_bf16 v[160:175], v[152:155], v[44:47], v[160:175]
    v_exp_f32 v26, v26
    v_exp_f32 v27, v27
    v_cvt_pk_bf16_f32 v40, v24, v25
    v_cvt_pk_bf16_f32 v41, v26, v27
    v_exp_f32 v28, v28
    v_exp_f32 v29, v29
    v_mfma_f32_32x32x16_bf16 v[8:23], v[128:131], v[100:103], 0
    v_exp_f32 v30, v30
    v_exp_f32 v31, v31
    v_cvt_pk_bf16_f32 v42, v28, v29
    v_cvt_pk_bf16_f32 v43, v30, v31
    v_mfma_f32_32x32x16_bf16 v[8:23], v[136:139], v[108:111], v[8:23]
    v_exp_f32 v32, v32
    v_exp_f32 v33, v33
    v_exp_f32 v34, v34
    v_exp_f32 v35, v35
    v_cvt_pk_bf16_f32 v44, v32, v33
    v_cvt_pk_bf16_f32 v45, v34, v35
    v_exp_f32 v36, v36
    v_exp_f32 v37, v37
    v_mfma_f32_32x32x16_bf16 v[176:191], v[144:147], v[40:43], v[176:191]
    v_exp_f32 v38, v38
    v_exp_f32 v39, v39
    v_cvt_pk_bf16_f32 v46, v36, v37
    v_cvt_pk_bf16_f32 v47, v38, v39
    v_exp_f32 v8, v8
    v_exp_f32 v9, v9
    v_mfma_f32_32x32x16_bf16 v[176:191], v[152:155], v[44:47], v[176:191]
    v_exp_f32 v10, v10
    v_exp_f32 v11, v11
    v_cvt_pk_bf16_f32 v40, v8, v9
    v_cvt_pk_bf16_f32 v41, v10, v11
    v_exp_f32 v12, v12
    v_exp_f32 v13, v13
    v_mfma_f32_32x32x16_bf16 v[24:39], v[128:131], v[116:119], 0
    v_exp_f32 v14, v14
    v_exp_f32 v15, v15
    v_cvt_pk_bf16_f32 v42, v12, v13
    v_cvt_pk_bf16_f32 v43, v14, v15
    v_mfma_f32_32x32x16_bf16 v[24:39], v[136:139], v[124:127], v[24:39]
    buffer_load_dwordx4 v[128:131], v63, s[36:39], s21 offen offset:0 sc1
    buffer_load_dwordx4 v[136:139], v63, s[36:39], s21 offen offset:1024 sc1
    v_exp_f32 v16, v16
    v_exp_f32 v17, v17
    v_exp_f32 v18, v18
    v_exp_f32 v19, v19
    v_cvt_pk_bf16_f32 v44, v16, v17
    v_cvt_pk_bf16_f32 v45, v18, v19
    v_exp_f32 v20, v20
    v_exp_f32 v21, v21
    v_mfma_f32_32x32x16_bf16 v[192:207], v[144:147], v[40:43], v[192:207]
    v_exp_f32 v22, v22
    v_exp_f32 v23, v23
    v_cvt_pk_bf16_f32 v46, v20, v21
    v_cvt_pk_bf16_f32 v47, v22, v23
    v_exp_f32 v24, v24
    v_exp_f32 v25, v25
    v_mfma_f32_32x32x16_bf16 v[192:207], v[152:155], v[44:47], v[192:207]
    v_exp_f32 v26, v26
    v_exp_f32 v27, v27
    v_cvt_pk_bf16_f32 v40, v24, v25
    v_cvt_pk_bf16_f32 v41, v26, v27
    v_exp_f32 v28, v28
    v_exp_f32 v29, v29
    s_waitcnt vmcnt(12)
    v_mfma_f32_32x32x16_bf16 v[8:23], v[132:135], v[68:71], 0
    v_exp_f32 v30, v30
    v_exp_f32 v31, v31
    v_cvt_pk_bf16_f32 v42, v28, v29
    v_cvt_pk_bf16_f32 v43, v30, v31
    v_mfma_f32_32x32x16_bf16 v[8:23], v[140:143], v[76:79], v[8:23]
    v_exp_f32 v32, v32
    v_exp_f32 v33, v33
    v_exp_f32 v34, v34
    v_exp_f32 v35, v35
    v_cvt_pk_bf16_f32 v44, v32, v33
    v_cvt_pk_bf16_f32 v45, v34, v35
    v_exp_f32 v36, v36
    v_exp_f32 v37, v37
    v_mfma_f32_32x32x16_bf16 v[208:223], v[144:147], v[40:43], v[208:223]
    v_exp_f32 v38, v38
    v_exp_f32 v39, v39
    v_cvt_pk_bf16_f32 v46, v36, v37
    v_cvt_pk_bf16_f32 v47, v38, v39
    v_exp_f32 v8, v8
    v_exp_f32 v9, v9
    v_mfma_f32_32x32x16_bf16 v[208:223], v[152:155], v[44:47], v[208:223]
    buffer_load_dwordx4 v[144:147], v63, s[36:39], s21 offen offset:2048 sc1
    buffer_load_dwordx4 v[152:155], v63, s[36:39], s21 offen offset:3072 sc1
    s_add_u32 s19, s19, 4096
    s_and_b32 s19, s19, 0xffff
    s_add_u32 s21, s20, s19
    v_exp_f32 v10, v10
    v_exp_f32 v11, v11
    v_cvt_pk_bf16_f32 v40, v8, v9
    v_cvt_pk_bf16_f32 v41, v10, v11
    v_exp_f32 v12, v12
    v_exp_f32 v13, v13
    v_mfma_f32_32x32x16_bf16 v[24:39], v[132:135], v[84:87], 0
    v_exp_f32 v14, v14
    v_exp_f32 v15, v15
    v_cvt_pk_bf16_f32 v42, v12, v13
    v_cvt_pk_bf16_f32 v43, v14, v15
    v_mfma_f32_32x32x16_bf16 v[24:39], v[140:143], v[92:95], v[24:39]
    v_exp_f32 v16, v16
    v_exp_f32 v17, v17
    v_exp_f32 v18, v18
    v_exp_f32 v19, v19
    v_cvt_pk_bf16_f32 v44, v16, v17
    v_cvt_pk_bf16_f32 v45, v18, v19
    v_exp_f32 v20, v20
    v_exp_f32 v21, v21
    s_waitcnt vmcnt(12)
    v_mfma_f32_32x32x16_bf16 v[160:175], v[148:151], v[40:43], v[160:175]
    v_exp_f32 v22, v22
    v_exp_f32 v23, v23
    v_cvt_pk_bf16_f32 v46, v20, v21
    v_cvt_pk_bf16_f32 v47, v22, v23
    v_exp_f32 v24, v24
    v_exp_f32 v25, v25
    v_mfma_f32_32x32x16_bf16 v[160:175], v[156:159], v[44:47], v[160:175]
    v_exp_f32 v26, v26
    v_exp_f32 v27, v27
    v_cvt_pk_bf16_f32 v40, v24, v25
    v_cvt_pk_bf16_f32 v41, v26, v27
    v_exp_f32 v28, v28
    v_exp_f32 v29, v29
    v_mfma_f32_32x32x16_bf16 v[8:23], v[132:135], v[100:103], 0
    v_exp_f32 v30, v30
    v_exp_f32 v31, v31
    v_cvt_pk_bf16_f32 v42, v28, v29
    v_cvt_pk_bf16_f32 v43, v30, v31
    v_mfma_f32_32x32x16_bf16 v[8:23], v[140:143], v[108:111], v[8:23]
    v_exp_f32 v32, v32
    v_exp_f32 v33, v33
    v_exp_f32 v34, v34
    v_exp_f32 v35, v35
    v_cvt_pk_bf16_f32 v44, v32, v33
    v_cvt_pk_bf16_f32 v45, v34, v35
    v_exp_f32 v36, v36
    v_exp_f32 v37, v37
    v_mfma_f32_32x32x16_bf16 v[176:191], v[148:151], v[40:43], v[176:191]
    v_exp_f32 v38, v38
    v_exp_f32 v39, v39
    v_cvt_pk_bf16_f32 v46, v36, v37
    v_cvt_pk_bf16_f32 v47, v38, v39
    v_exp_f32 v8, v8
    v_exp_f32 v9, v9
    v_mfma_f32_32x32x16_bf16 v[176:191], v[156:159], v[44:47], v[176:191]
    v_exp_f32 v10, v10
    v_exp_f32 v11, v11
    v_cvt_pk_bf16_f32 v40, v8, v9
    v_cvt_pk_bf16_f32 v41, v10, v11
    v_exp_f32 v12, v12
    v_exp_f32 v13, v13
    v_mfma_f32_32x32x16_bf16 v[24:39], v[132:135], v[116:119], 0
    v_exp_f32 v14, v14
    v_exp_f32 v15, v15
    v_cvt_pk_bf16_f32 v42, v12, v13
    v_cvt_pk_bf16_f32 v43, v14, v15
    v_mfma_f32_32x32x16_bf16 v[24:39], v[140:143], v[124:127], v[24:39]
    buffer_load_dwordx4 v[132:135], v63, s[36:39], s21 offen offset:0 sc1
    buffer_load_dwordx4 v[140:143], v63, s[36:39], s21 offen offset:1024 sc1
    v_exp_f32 v16, v16
    v_exp_f32 v17, v17
    v_exp_f32 v18, v18
    v_exp_f32 v19, v19
    v_cvt_pk_bf16_f32 v44, v16, v17
    v_cvt_pk_bf16_f32 v45, v18, v19
    v_exp_f32 v20, v20
    v_exp_f32 v21, v21
    v_mfma_f32_32x32x16_bf16 v[192:207], v[148:151], v[40:43], v[192:207]
    v_exp_f32 v22, v22
    v_exp_f32 v23, v23
    v_cvt_pk_bf16_f32 v46, v20, v21
    v_cvt_pk_bf16_f32 v47, v22, v23
    v_exp_f32 v24, v24
    v_exp_f32 v25, v25
    v_mfma_f32_32x32x16_bf16 v[192:207], v[156:159], v[44:47], v[192:207]
    v_exp_f32 v26, v26
    v_exp_f32 v27, v27
    v_cvt_pk_bf16_f32 v40, v24, v25
    v_cvt_pk_bf16_f32 v41, v26, v27
    v_exp_f32 v28, v28
    v_exp_f32 v29, v29
    s_waitcnt vmcnt(12)
    v_mfma_f32_32x32x16_bf16 v[8:23], v[64:67], v[68:71], 0
    v_exp_f32 v30, v30
    v_exp_f32 v31, v31
    v_cvt_pk_bf16_f32 v42, v28, v29
    v_cvt_pk_bf16_f32 v43, v30, v31
    v_mfma_f32_32x32x16_bf16 v[8:23], v[72:75], v[76:79], v[8:23]
    v_exp_f32 v32, v32
    v_exp_f32 v33, v33
    v_exp_f32 v34, v34
    v_exp_f32 v35, v35
    v_cvt_pk_bf16_f32 v44, v32, v33
    v_cvt_pk_bf16_f32 v45, v34, v35
    v_exp_f32 v36, v36
    v_exp_f32 v37, v37
    v_mfma_f32_32x32x16_bf16 v[208:223], v[148:151], v[40:43], v[208:223]
    v_exp_f32 v38, v38
    v_exp_f32 v39, v39
    v_cvt_pk_bf16_f32 v46, v36, v37
    v_cvt_pk_bf16_f32 v47, v38, v39
    s_add_u32 s69, s69, 4
    s_cmp_lt_u32 s69, 16
    s_cbranch_scc1 L_ALOOP
    s_nop 0
    v_mfma_f32_32x32x16_bf16 v[208:223], v[156:159], v[44:47], v[208:223]
    s_add_u32 s60, s56, 1
    s_and_b32 s60, s60, 3
    s_mul_i32 s60, s60, 33792
    v_add_u32 v49, s60, v2
    s_add_u32 s60, s56, 2
    s_and_b32 s60, s60, 3
    s_mul_i32 s60, s60, 33792
    v_add_u32 v50, s60, v2
    s_add_u32 s60, s56, 3
    s_and_b32 s60, s60, 3
    s_mul_i32 s60, s60, 33792
    v_add_u32 v51, s60, v2
    s_mul_i32 s60, s56, 33792
    v_add_u32 v3, s60, v2
    v_mov_b32 v6, 151556
    ds_write_b128 v49, v[176:179] offset:0
    ds_write_b128 v49, v[180:183] offset:1024
    ds_write_b128 v49, v[184:187] offset:2048
    ds_write_b128 v49, v[188:191] offset:3072
    ds_write_b128 v50, v[192:195] offset:4096
    ds_write_b128 v50, v[196:199] offset:5120
    ds_write_b128 v50, v[200:203] offset:6144
    ds_write_b128 v50, v[204:207] offset:7168
    ds_write_b128 v51, v[208:211] offset:8192
    ds_write_b128 v51, v[212:215] offset:9216
    ds_write_b128 v51, v[216:219] offset:10240
    ds_write_b128 v51, v[220:223] offset:11264
    s_waitcnt lgkmcnt(0)
    s_mov_b64 exec, 1
    v_mov_b32 v7, 1
    ds_add_u32 v6, v7
    s_mov_b64 exec, -1
    s_mov_b32 s62, 0
LS_66:
    ds_read_b32 v7, v6
    s_waitcnt lgkmcnt(0)
    v_cmp_gt_u32 vcc, 4, v7
    s_add_u32 s62, s62, 1
    s_cbranch_vccz LSD_67
    s_sleep 1
    s_cmp_lt_u32 s62, 0x1000000
    s_cbranch_scc1 LS_66
LSD_67:
    ds_read_b128 v[176:179], v3 offset:0
    ds_read_b128 v[180:183], v3 offset:1024
    ds_read_b128 v[184:187], v3 offset:2048
    ds_read_b128 v[188:191], v3 offset:3072
    ds_read_b128 v[192:195], v3 offset:4096
    ds_read_b128 v[196:199], v3 offset:5120
    ds_read_b128 v[200:203], v3 offset:6144
    ds_read_b128 v[204:207], v3 offset:7168
    ds_read_b128 v[208:211], v3 offset:8192
    ds_read_b128 v[212:215], v3 offset:9216
    ds_read_b128 v[216:219], v3 offset:10240
    ds_read_b128 v[220:223], v3 offset:11264
    s_waitcnt lgkmcnt(8)
    v_pk_add_f32 v[160:161], v[160:161], v[176:177]
    v_pk_add_f32 v[162:163], v[162:163], v[178:179]
    v_pk_add_f32 v[164:165], v[164:165], v[180:181]
    v_pk_add_f32 v[166:167], v[166:167], v[182:183]
    v_pk_add_f32 v[168:169], v[168:169], v[184:185]
    v_pk_add_f32 v[170:171], v[170:171], v[186:187]
    v_pk_add_f32 v[172:173], v[172:173], v[188:189]
    v_pk_add_f32 v[174:175], v[174:175], v[190:191]
    s_waitcnt lgkmcnt(4)
    v_pk_add_f32 v[160:161], v[160:161], v[192:193]
    v_pk_add_f32 v[162:163], v[162:163], v[194:195]
    v_pk_add_f32 v[164:165], v[164:165], v[196:197]
    v_pk_add_f32 v[166:167], v[166:167], v[198:199]
    v_pk_add_f32 v[168:169], v[168:169], v[200:201]
    v_pk_add_f32 v[170:171], v[170:171], v[202:203]
    v_pk_add_f32 v[172:173], v[172:173], v[204:205]
    v_pk_add_f32 v[174:175], v[174:175], v[206:207]
    s_waitcnt lgkmcnt(0)
    v_pk_add_f32 v[160:161], v[160:161], v[208:209]
    v_pk_add_f32 v[162:163], v[162:163], v[210:211]
    v_pk_add_f32 v[164:165], v[164:165], v[212:213]
    v_pk_add_f32 v[166:167], v[166:167], v[214:215]
    v_pk_add_f32 v[168:169], v[168:169], v[216:217]
    v_pk_add_f32 v[170:171], v[170:171], v[218:219]
    v_pk_add_f32 v[172:173], v[172:173], v[220:221]
    v_pk_add_f32 v[174:175], v[174:175], v[222:223]
    s_mov_b32 s69, 0
L_NORM:
    v_mov_b32 v52, v167
    v_mov_b32 v53, v167
    s_nop 1
    v_permlane32_swap_b32 v52, v53
    s_mov_b32 s60, 0xd800000
    s_mov_b32 s61, 0x71800000
    v_cmp_le_f32 s[62:63], s60, v52
    v_cmp_ge_f32 s[64:65], s61, v52
    v_rcp_f32 v52, v52
    v_mov_b32 v55, 0x10000
    s_mov_b32 s60, 0xffff
    v_mul_f32 v160, v160, v52
    v_mul_f32 v161, v161, v52
    v_mul_f32 v162, v162, v52
    v_mul_f32 v163, v163, v52
    v_mul_f32 v164, v164, v52
    v_mul_f32 v165, v165, v52
    v_mul_f32 v166, v166, v52
    v_mul_f32 v167, v167, v52
    v_mul_f32 v168, v168, v52
    v_mul_f32 v169, v169, v52
    v_mul_f32 v170, v170, v52
    v_mul_f32 v171, v171, v52
    v_mul_f32 v172, v172, v52
    v_mul_f32 v173, v173, v52
    v_mul_f32 v174, v174, v52
    v_mul_f32 v175, v175, v52
    v_mul_f32 v53, 0, v160
    v_mul_f32 v54, 0, v161
    v_fmac_f32 v53, 0, v162
    v_fmac_f32 v54, 0, v163
    v_fmac_f32 v53, 0, v164
    v_fmac_f32 v54, 0, v165
    v_fmac_f32 v53, 0, v166
    v_fmac_f32 v54, 0, v167
    v_fmac_f32 v53, 0, v168
    v_fmac_f32 v54, 0, v169
    v_fmac_f32 v53, 0, v170
    v_fmac_f32 v54, 0, v171
    v_fmac_f32 v53, 0, v172
    v_fmac_f32 v54, 0, v173
    v_fmac_f32 v53, 0, v174
    v_fmac_f32 v54, 0, v175
    v_add_f32 v53, v53, v54
    s_and_b64 s[62:63], s[62:63], s[64:65]
    v_cmp_eq_f32 vcc, 0, v53
    s_and_b64 vcc, vcc, s[62:63]
    s_cmp_eq_u64 vcc, -1
    s_cselect_b32 s60, 1, s69
    s_cmp_eq_u32 s60, 0
    s_cbranch_scc1 L_FALLBACK
    v_cvt_pk_bf16_f32 v40, v160, v161
    v_cvt_pk_bf16_f32 v41, v162, v163
    v_cvt_pk_bf16_f32 v42, v164, v165
    v_cvt_pk_bf16_f32 v43, v166, v167
    v_cvt_pk_bf16_f32 v44, v168, v169
    v_cvt_pk_bf16_f32 v45, v170, v171
    v_cvt_pk_bf16_f32 v46, v172, v173
    v_cvt_pk_bf16_f32 v47, v174, v175
    s_mov_b32 s62, 0xffff
    v_and_or_b32 v43, v43, s62, v55
    v_and_or_b32 v47, v47, s62, v55
    s_lshl_b32 s60, s17, 2
    s_add_u32 s60, s60, s56
    s_lshl_b32 s60, s60, 4
    s_add_u32 s60, s60, s18
    s_lshl_b32 s61, s60, 11
    s_add_u32 s61, s61, 9707520
    buffer_store_dwordx4 v[40:43], v2, s[36:39], s61 offen sc1
    buffer_store_dwordx4 v[44:47], v2, s[36:39], s61 offen offset:1024 sc1
    s_barrier
    s_endpgm
L_FALLBACK:
    s_mov_b32 s69, 1
    s_waitcnt vmcnt(0)
    s_lshl_b32 s60, s17, 4
    s_add_u32 s60, s60, s18
    s_lshl_b32 s60, s60, 13
    s_lshl_b32 s61, s56, 11
    s_add_u32 s60, s60, s61
    s_add_u32 s60, s60, 7340032
    buffer_load_dwordx4 v[64:67], v2, s[36:39], s60 offen sc1
    buffer_load_dwordx4 v[68:71], v2, s[36:39], s60 offen offset:1024 sc1
    v_and_b32 v3, 3, v1
    v_lshrrev_b32 v4, 2, v1
    v_lshl_add_u32 v3, v4, 4, v3
    v_lshlrev_b32 v3, 2, v3
    s_mov_b32 s61, 11804672
    s_mov_b32 s62, 0
POLL_68:
    buffer_load_dword v4, v3, s[36:39], s61 offen sc1
    s_waitcnt vmcnt(0)
    v_cmp_ne_u32 vcc, s57, v4
    s_add_u32 s62, s62, 1
    s_cbranch_vccz POLLD_69
    s_sleep 1
    s_cmp_lt_u32 s62, 0x100000
    s_cbranch_scc1 POLL_68
POLLD_69:
    v_mov_b32 v160, 0
    v_mov_b32 v161, 0
    v_mov_b32 v162, 0
    v_mov_b32 v163, 0
    v_mov_b32 v164, 0
    v_mov_b32 v165, 0
    v_mov_b32 v166, 0
    v_mov_b32 v167, 0
    v_mov_b32 v168, 0
    v_mov_b32 v169, 0
    v_mov_b32 v170, 0
    v_mov_b32 v171, 0
    v_mov_b32 v172, 0
    v_mov_b32 v173, 0
    v_mov_b32 v174, 0
    v_mov_b32 v175, 0
    v_mov_b32 v104, 0xff800000
    s_mov_b32 s60, 9437184
    s_mov_b32 s61, 0
L_FB_LOOP:
    buffer_load_dwordx4 v[72:75], v2, s[36:39], s60 offen offset:0 sc1
    buffer_load_dwordx4 v[76:79], v2, s[36:39], s60 offen offset:1024 sc1
    buffer_load_dwordx4 v[80:83], v2, s[36:39], s60 offen offset:2048 sc1
    buffer_load_dwordx4 v[84:87], v2, s[36:39], s60 offen offset:3072 sc1
    s_waitcnt vmcnt(0)
    v_mfma_f32_32x32x16_bf16 v[88:103], v[72:75], v[64:67], 0
    v_mfma_f32_32x32x16_bf16 v[88:103], v[76:79], v[68:71], v[88:103]
    s_nop 7
    s_nop 7
    v_max3_f32 v105, v88, v89, v104
    v_max3_f32 v105, v105, v90, v91
    v_max3_f32 v105, v105, v92, v93
    v_max3_f32 v105, v105, v94, v95
    v_max3_f32 v105, v105, v96, v97
    v_max3_f32 v105, v105, v98, v99
    v_max3_f32 v105, v105, v100, v101
    v_max3_f32 v105, v105, v102, v103
    v_mov_b32 v106, v105
    s_nop 1
    v_permlane32_swap_b32 v105, v106
    v_max_f32 v105, v105, v106
    v_sub_f32 v106, v104, v105
    v_exp_f32 v106, v106
    v_mov_b32 v104, v105
    v_sub_f32 v88, v88, v105
    v_sub_f32 v89, v89, v105
    v_sub_f32 v90, v90, v105
    v_sub_f32 v91, v91, v105
    v_sub_f32 v92, v92, v105
    v_sub_f32 v93, v93, v105
    v_sub_f32 v94, v94, v105
    v_sub_f32 v95, v95, v105
    v_sub_f32 v96, v96, v105
    v_sub_f32 v97, v97, v105
    v_sub_f32 v98, v98, v105
    v_sub_f32 v99, v99, v105
    v_sub_f32 v100, v100, v105
    v_sub_f32 v101, v101, v105
    v_sub_f32 v102, v102, v105
    v_sub_f32 v103, v103, v105
    v_exp_f32 v88, v88
    v_exp_f32 v89, v89
    v_exp_f32 v90, v90
    v_exp_f32 v91, v91
    v_exp_f32 v92, v92
    v_exp_f32 v93, v93
    v_exp_f32 v94, v94
    v_exp_f32 v95, v95
    v_exp_f32 v96, v96
    v_exp_f32 v97, v97
    v_exp_f32 v98, v98
    v_exp_f32 v99, v99
    v_exp_f32 v100, v100
    v_exp_f32 v101, v101
    v_exp_f32 v102, v102
    v_exp_f32 v103, v103
    v_mul_f32 v160, v160, v106
    v_mul_f32 v161, v161, v106
    v_mul_f32 v162, v162, v106
    v_mul_f32 v163, v163, v106
    v_mul_f32 v164, v164, v106
    v_mul_f32 v165, v165, v106
    v_mul_f32 v166, v166, v106
    v_mul_f32 v167, v167, v106
    v_mul_f32 v168, v168, v106
    v_mul_f32 v169, v169, v106
    v_mul_f32 v170, v170, v106
    v_mul_f32 v171, v171, v106
    v_mul_f32 v172, v172, v106
    v_mul_f32 v173, v173, v106
    v_mul_f32 v174, v174, v106
    v_mul_f32 v175, v175, v106
    v_cvt_pk_bf16_f32 v40, v88, v89
    v_cvt_pk_bf16_f32 v41, v90, v91
    v_cvt_pk_bf16_f32 v42, v92, v93
    v_cvt_pk_bf16_f32 v43, v94, v95
    v_cvt_pk_bf16_f32 v44, v96, v97
    v_cvt_pk_bf16_f32 v45, v98, v99
    v_cvt_pk_bf16_f32 v46, v100, v101
    v_cvt_pk_bf16_f32 v47, v102, v103
    s_nop 1
    v_mfma_f32_32x32x16_bf16 v[160:175], v[80:83], v[40:43], v[160:175]
    v_mfma_f32_32x32x16_bf16 v[160:175], v[84:87], v[44:47], v[160:175]
    s_add_u32 s60, s60, 4096
    s_add_u32 s61, s61, 1
    s_nop 7
    s_nop 7
    s_cmp_lt_u32 s61, 64
    s_cbranch_scc1 L_FB_LOOP
    s_branch L_NORM
L_G:
    s_cmp_lt_u32 s59, 28
    s_cbranch_scc1 L_G_WORK
    s_waitcnt vmcnt(0)
    s_mov_b64 exec, 1
    v_mov_b32 v32, 151552
    v_mov_b32 v33, 1
    ds_add_rtn_u32 v33, v32, v33
    s_waitcnt lgkmcnt(0)
    v_readfirstlane_b32 s60, v33
    s_cmp_lg_u32 s60, 7
    s_cbranch_scc1 PB_70
    v_mov_b32 v32, 0
    v_mov_b32 v33, s57
    buffer_store_dword v33, v32, s[36:39], s6 offen sc1
PB_70:
    s_mov_b64 exec, -1
    s_endpgm
L_G_WORK:
    s_sub_u32 s66, s56, 4
    s_mov_b32 s4, s16
    v_lshrrev_b32 v32, 5, v1
    v_bfe_u32 v33, v1, 2, 2
    v_lshl_add_u32 v32, v32, 2, v33
    v_lshlrev_b32 v32, 7, v32
    v_bfe_u32 v33, v1, 4, 1
    v_lshl_add_u32 v32, v33, 5, v32
    v_and_b32 v33, 3, v1
    v_lshl_add_u32 v32, v33, 3, v32
    v_bfe_u32 v33, v1, 3, 1
    v_lshl_add_u32 v4, v33, 6, v32
    v_add_u32 v4, s4, v4
    v_xor_b32 v5, 64, v4
    v_lshrrev_b32 v32, 3, v1
    v_mul_u32_u24 v40, 896, v32
    v_and_b32 v34, 7, v1
    v_lshl_add_u32 v40, v34, 4, v40
    v_lshlrev_b32 v37, 2, v32
    s_add_u32 s3, s15, 114688
    s_lshl_b32 s65, s66, 4
    s_add_u32 s65, s65, 48
    s_add_u32 s65, s65, s22
    s_mul_i32 s64, s13, 229376
    s_lshl_b32 s60, s65, 10
    s_add_u32 s64, s64, s60
    s_mul_i32 s65, s65, 14336
    s_lshl_b32 s60, s14, 7
    s_add_u32 s65, s65, s60
    s_mov_b32 s24, s22
    s_mov_b32 s25, s22
    s_mov_b32 s27, 1024
    s_mov_b32 s26, 4294951936
    s_mov_b32 s29, 7168
    s_mov_b32 s28, 4294745088
    v_and_b32 v35, 3, v1
    s_lshl_b32 s60, s66, 2
    v_add_u32 v35, s60, v35
    v_lshlrev_b32 v35, 2, v35
    s_add_u32 s63, s10, 1024
    s_lshl_b32 s60, s13, 8
    s_lshl_b32 s61, s66, 6
    s_add_u32 s60, s60, s61
    s_add_u32 s60, s60, 9699328
    buffer_load_dword v38, v37, s[36:39], s60 offen sc1
    buffer_load_dword v39, v37, s[36:39], s60 offen offset:32 sc1
    s_waitcnt vmcnt(8)
    ds_read_b64_tr_b16 v[16:17], v4 offset:0
    ds_read_b64_tr_b16 v[18:19], v4 offset:1024
    ds_read_b64_tr_b16 v[20:21], v5 offset:0
    ds_read_b64_tr_b16 v[22:23], v5 offset:1024
    ds_read_b64_tr_b16 v[24:25], v4 offset:2048
    ds_read_b64_tr_b16 v[26:27], v4 offset:3072
    ds_read_b64_tr_b16 v[28:29], v5 offset:2048
    ds_read_b64_tr_b16 v[30:31], v5 offset:3072
    s_waitcnt lgkmcnt(4)
    v_mfma_f32_32x32x16_bf16 v[160:175], v[16:19], v[64:67], 0
    v_mfma_f32_32x32x16_bf16 v[176:191], v[20:23], v[64:67], 0
    v_mfma_f32_32x32x16_bf16 v[192:207], v[16:19], v[68:71], 0
    v_mfma_f32_32x32x16_bf16 v[208:223], v[20:23], v[68:71], 0
    s_mov_b64 exec, 1
    v_mov_b32 v41, 151552
    v_mov_b32 v42, 1
    ds_add_rtn_u32 v42, v41, v42
    s_waitcnt lgkmcnt(0)
    v_readfirstlane_b32 s60, v42
    s_cmp_lg_u32 s60, 7
    s_cbranch_scc1 PB_71
    v_mov_b32 v41, 0
    v_mov_b32 v42, s57
    buffer_store_dword v42, v41, s[36:39], s6 offen sc1
PB_71:
    s_mov_b64 exec, -1
    buffer_load_dwordx4 v[96:99], v63, s[36:39], s8 offen sc1
    buffer_load_dwordx4 v[100:103], v63, s[36:39], s9 offen sc1
    s_add_u32 s8, s8, 1024
    s_add_u32 s31, s31, 1024
    s_and_b32 s31, s31, s5
    s_add_u32 s9, s30, s31
    buffer_load_dwordx4 v[104:107], v63, s[36:39], s8 offen sc1
    buffer_load_dwordx4 v[108:111], v63, s[36:39], s9 offen sc1
    s_add_u32 s8, s8, 1024
    s_add_u32 s31, s31, 1024
    s_and_b32 s31, s31, s5
    s_add_u32 s9, s30, s31
    ds_read_b64_tr_b16 v[16:17], v4 offset:4096
    ds_read_b64_tr_b16 v[18:19], v4 offset:5120
    ds_read_b64_tr_b16 v[20:21], v5 offset:4096
    ds_read_b64_tr_b16 v[22:23], v5 offset:5120
    s_waitcnt vmcnt(10)
    s_waitcnt lgkmcnt(4)
    v_mfma_f32_32x32x16_bf16 v[160:175], v[24:27], v[72:75], v[160:175]
    v_mfma_f32_32x32x16_bf16 v[176:191], v[28:31], v[72:75], v[176:191]
    v_mfma_f32_32x32x16_bf16 v[192:207], v[24:27], v[76:79], v[192:207]
    v_mfma_f32_32x32x16_bf16 v[208:223], v[28:31], v[76:79], v[208:223]
    buffer_load_dwordx4 v[112:115], v63, s[36:39], s8 offen sc1
    buffer_load_dwordx4 v[116:119], v63, s[36:39], s9 offen sc1
    s_add_u32 s8, s8, 1024
    s_add_u32 s31, s31, 1024
    s_and_b32 s31, s31, s5
    s_add_u32 s9, s30, s31
    buffer_load_dwordx4 v[120:123], v63, s[36:39], s8 offen sc1
    buffer_load_dwordx4 v[124:127], v63, s[36:39], s9 offen sc1
    s_add_u32 s8, s8, 1024
    s_mov_b32 s9, s11
    ds_read_b64_tr_b16 v[24:25], v4 offset:6144
    ds_read_b64_tr_b16 v[26:27], v4 offset:7168
    ds_read_b64_tr_b16 v[28:29], v5 offset:6144
    ds_read_b64_tr_b16 v[30:31], v5 offset:7168
    s_waitcnt vmcnt(12)
    s_waitcnt lgkmcnt(4)
    v_mfma_f32_32x32x16_bf16 v[160:175], v[16:19], v[80:83], v[160:175]
    v_mfma_f32_32x32x16_bf16 v[176:191], v[20:23], v[80:83], v[176:191]
    v_mfma_f32_32x32x16_bf16 v[192:207], v[16:19], v[84:87], v[192:207]
    v_mfma_f32_32x32x16_bf16 v[208:223], v[20:23], v[84:87], v[208:223]
    buffer_load_dwordx4 v[128:131], v63, s[36:39], s8 offen sc1
    buffer_load_dwordx4 v[132:135], v63, s[36:39], s9 offen sc1
    s_add_u32 s8, s8, 1024
    s_add_u32 s9, s9, 1024
    buffer_load_dwordx4 v[136:139], v63, s[36:39], s8 offen sc1
    buffer_load_dwordx4 v[140:143], v63, s[36:39], s9 offen sc1
    s_add_u32 s8, s8, 1024
    s_add_u32 s9, s9, 1024
    ds_read_b64_tr_b16 v[16:17], v4 offset:8192
    ds_read_b64_tr_b16 v[18:19], v4 offset:9216
    ds_read_b64_tr_b16 v[20:21], v5 offset:8192
    ds_read_b64_tr_b16 v[22:23], v5 offset:9216
    s_waitcnt vmcnt(14)
    s_waitcnt lgkmcnt(4)
    v_mfma_f32_32x32x16_bf16 v[160:175], v[24:27], v[88:91], v[160:175]
    v_mfma_f32_32x32x16_bf16 v[176:191], v[28:31], v[88:91], v[176:191]
    v_mfma_f32_32x32x16_bf16 v[192:207], v[24:27], v[92:95], v[192:207]
    v_mfma_f32_32x32x16_bf16 v[208:223], v[28:31], v[92:95], v[208:223]
    s_add_u32 m0, s4, 0
    s_nop 0
    buffer_load_dwordx4 v62, s[40:43], s3 offen lds
    s_add_u32 m0, s4, 1024
    s_add_u32 s3, s3, 7168
    buffer_load_dwordx4 v62, s[40:43], s3 offen lds
    s_add_u32 s3, s3, 7168
    buffer_load_dwordx4 v[144:147], v63, s[36:39], s8 offen sc1
    buffer_load_dwordx4 v[148:151], v63, s[36:39], s9 offen sc1
    s_add_u32 s8, s8, 1024
    s_add_u32 s9, s9, 1024
    buffer_load_dwordx4 v[152:155], v63, s[36:39], s8 offen sc1
    buffer_load_dwordx4 v[156:159], v63, s[36:39], s9 offen sc1
    s_add_u32 s8, s8, 1024
    s_add_u32 s9, s9, 1024
    ds_read_b64_tr_b16 v[24:25], v4 offset:10240
    ds_read_b64_tr_b16 v[26:27], v4 offset:11264
    ds_read_b64_tr_b16 v[28:29], v5 offset:10240
    ds_read_b64_tr_b16 v[30:31], v5 offset:11264
    s_waitcnt vmcnt(16)
    s_waitcnt lgkmcnt(4)
    v_mfma_f32_32x32x16_bf16 v[160:175], v[16:19], v[96:99], v[160:175]
    v_mfma_f32_32x32x16_bf16 v[176:191], v[20:23], v[96:99], v[176:191]
    v_mfma_f32_32x32x16_bf16 v[192:207], v[16:19], v[100:103], v[192:207]
    v_mfma_f32_32x32x16_bf16 v[208:223], v[20:23], v[100:103], v[208:223]
    s_add_u32 m0, s4, 2048
    s_nop 0
    buffer_load_dwordx4 v62, s[40:43], s3 offen lds
    s_add_u32 m0, s4, 3072
    s_add_u32 s3, s3, 7168
    buffer_load_dwordx4 v62, s[40:43], s3 offen lds
    s_add_u32 s3, s3, 7168
    ds_read_b64_tr_b16 v[16:17], v4 offset:12288
    ds_read_b64_tr_b16 v[18:19], v4 offset:13312
    ds_read_b64_tr_b16 v[20:21], v5 offset:12288
    ds_read_b64_tr_b16 v[22:23], v5 offset:13312
    s_waitcnt vmcnt(16)
    s_waitcnt lgkmcnt(4)
    v_mfma_f32_32x32x16_bf16 v[160:175], v[24:27], v[104:107], v[160:175]
    v_mfma_f32_32x32x16_bf16 v[176:191], v[28:31], v[104:107], v[176:191]
    v_mfma_f32_32x32x16_bf16 v[192:207], v[24:27], v[108:111], v[192:207]
    v_mfma_f32_32x32x16_bf16 v[208:223], v[28:31], v[108:111], v[208:223]
    s_add_u32 m0, s4, 4096
    s_nop 0
    buffer_load_dwordx4 v62, s[40:43], s3 offen lds
    s_add_u32 m0, s4, 5120
    s_add_u32 s3, s3, 7168
    buffer_load_dwordx4 v62, s[40:43], s3 offen lds
    s_add_u32 s3, s3, 7168
    ds_read_b64_tr_b16 v[24:25], v4 offset:14336
    ds_read_b64_tr_b16 v[26:27], v4 offset:15360
    ds_read_b64_tr_b16 v[28:29], v5 offset:14336
    ds_read_b64_tr_b16 v[30:31], v5 offset:15360
    s_waitcnt vmcnt(16)
    s_waitcnt lgkmcnt(4)
    v_mfma_f32_32x32x16_bf16 v[160:175], v[16:19], v[112:115], v[160:175]
    v_mfma_f32_32x32x16_bf16 v[176:191], v[20:23], v[112:115], v[176:191]
    v_mfma_f32_32x32x16_bf16 v[192:207], v[16:19], v[116:119], v[192:207]
    v_mfma_f32_32x32x16_bf16 v[208:223], v[20:23], v[116:119], v[208:223]
    s_add_u32 m0, s4, 6144
    s_nop 0
    buffer_load_dwordx4 v62, s[40:43], s3 offen lds
    s_add_u32 m0, s4, 7168
    s_add_u32 s3, s3, 7168
    buffer_load_dwordx4 v62, s[40:43], s3 offen lds
    s_add_u32 s3, s3, 7168
    s_mov_b32 s3, s65
    s_waitcnt vmcnt(10)
    ds_read_b64_tr_b16 v[16:17], v4 offset:0
    ds_read_b64_tr_b16 v[18:19], v4 offset:1024
    ds_read_b64_tr_b16 v[20:21], v5 offset:0
    ds_read_b64_tr_b16 v[22:23], v5 offset:1024
    s_waitcnt lgkmcnt(4)
    v_mfma_f32_32x32x16_bf16 v[160:175], v[24:27], v[120:123], v[160:175]
    v_mfma_f32_32x32x16_bf16 v[176:191], v[28:31], v[120:123], v[176:191]
    v_mfma_f32_32x32x16_bf16 v[192:207], v[24:27], v[124:127], v[192:207]
    v_mfma_f32_32x32x16_bf16 v[208:223], v[28:31], v[124:127], v[208:223]
    s_add_u32 m0, s4, 8192
    s_add_u32 s25, s25, 1
    buffer_load_dwordx4 v62, s[40:43], s3 offen lds
    s_add_u32 m0, s4, 9216
    s_add_u32 s3, s3, 7168
    buffer_load_dwordx4 v62, s[40:43], s3 offen lds
    s_cmp_eq_u32 s25, 16
    s_cselect_b32 s60, s28, s29
    s_add_u32 s3, s3, s60
    buffer_load_dword v34, v35, s[36:39], s63 offen sc1
    s_waitcnt vmcnt(7)
    ds_read_b64_tr_b16 v[24:25], v4 offset:2048
    ds_read_b64_tr_b16 v[26:27], v4 offset:3072
    ds_read_b64_tr_b16 v[28:29], v5 offset:2048
    ds_read_b64_tr_b16 v[30:31], v5 offset:3072
    s_waitcnt lgkmcnt(4)
    v_mfma_f32_32x32x16_bf16 v[160:175], v[16:19], v[128:131], v[160:175]
    v_mfma_f32_32x32x16_bf16 v[176:191], v[20:23], v[128:131], v[176:191]
    v_mfma_f32_32x32x16_bf16 v[192:207], v[16:19], v[132:135], v[192:207]
    v_mfma_f32_32x32x16_bf16 v[208:223], v[20:23], v[132:135], v[208:223]
    s_add_u32 m0, s4, 10240
    s_add_u32 s25, s25, 1
    buffer_load_dwordx4 v62, s[40:43], s3 offen lds
    s_add_u32 m0, s4, 11264
    s_add_u32 s3, s3, 7168
    buffer_load_dwordx4 v62, s[40:43], s3 offen lds
    s_cmp_eq_u32 s25, 16
    s_cselect_b32 s60, s28, s29
    s_add_u32 s3, s3, s60
    s_waitcnt vmcnt(7)
    ds_read_b64_tr_b16 v[16:17], v4 offset:4096
    ds_read_b64_tr_b16 v[18:19], v4 offset:5120
    ds_read_b64_tr_b16 v[20:21], v5 offset:4096
    ds_read_b64_tr_b16 v[22:23], v5 offset:5120
    s_waitcnt lgkmcnt(4)
    v_mfma_f32_32x32x16_bf16 v[160:175], v[24:27], v[136:139], v[160:175]
    v_mfma_f32_32x32x16_bf16 v[176:191], v[28:31], v[136:139], v[176:191]
    v_mfma_f32_32x32x16_bf16 v[192:207], v[24:27], v[140:143], v[192:207]
    v_mfma_f32_32x32x16_bf16 v[208:223], v[28:31], v[140:143], v[208:223]
    s_add_u32 m0, s4, 12288
    s_add_u32 s25, s25, 1
    buffer_load_dwordx4 v62, s[40:43], s3 offen lds
    s_add_u32 m0, s4, 13312
    s_add_u32 s3, s3, 7168
    buffer_load_dwordx4 v62, s[40:43], s3 offen lds
    s_cmp_eq_u32 s25, 16
    s_cselect_b32 s60, s28, s29
    s_add_u32 s3, s3, s60
    s_waitcnt vmcnt(7)
    ds_read_b64_tr_b16 v[24:25], v4 offset:6144
    ds_read_b64_tr_b16 v[26:27], v4 offset:7168
    ds_read_b64_tr_b16 v[28:29], v5 offset:6144
    ds_read_b64_tr_b16 v[30:31], v5 offset:7168
    s_waitcnt lgkmcnt(4)
    v_mfma_f32_32x32x16_bf16 v[160:175], v[16:19], v[144:147], v[160:175]
    v_mfma_f32_32x32x16_bf16 v[176:191], v[20:23], v[144:147], v[176:191]
    v_mfma_f32_32x32x16_bf16 v[192:207], v[16:19], v[148:151], v[192:207]
    v_mfma_f32_32x32x16_bf16 v[208:223], v[20:23], v[148:151], v[208:223]
    s_add_u32 m0, s4, 14336
    s_add_u32 s25, s25, 1
    buffer_load_dwordx4 v62, s[40:43], s3 offen lds
    s_add_u32 m0, s4, 15360
    s_add_u32 s3, s3, 7168
    buffer_load_dwordx4 v62, s[40:43], s3 offen lds
    s_cmp_eq_u32 s25, 16
    s_cselect_b32 s60, s28, s29
    s_add_u32 s3, s3, s60
    s_waitcnt vmcnt(6)
    v_cmp_ne_u32 vcc, s57, v34
    s_nop 1
    s_cbranch_vccz LATEOK_72
    s_mov_b32 s62, 0
POLL_73:
    buffer_load_dword v34, v35, s[36:39], s63 offen sc1
    s_waitcnt vmcnt(0)
    v_cmp_ne_u32 vcc, s57, v34
    s_add_u32 s62, s62, 1
    s_cbranch_vccz POLLD_74
    s_sleep 2
    s_cmp_lt_u32 s62, 0x100000
    s_cbranch_scc1 POLL_73
POLLD_74:
LATEOK_72:
    s_mov_b32 s8, s64
    s_add_u32 s9, s64, 114688
    buffer_load_dwordx4 v[64:67], v63, s[36:39], s8 offen sc1
    buffer_load_dwordx4 v[68:71], v63, s[36:39], s9 offen sc1
    s_add_u32 s24, s24, 1
    s_cmp_eq_u32 s24, 16
    s_cselect_b32 s60, s26, s27
    s_add_u32 s8, s8, s60
    s_add_u32 s9, s9, s60
    buffer_load_dwordx4 v[72:75], v63, s[36:39], s8 offen sc1
    buffer_load_dwordx4 v[76:79], v63, s[36:39], s9 offen sc1
    s_add_u32 s24, s24, 1
    s_cmp_eq_u32 s24, 16
    s_cselect_b32 s60, s26, s27
    s_add_u32 s8, s8, s60
    s_add_u32 s9, s9, s60
    buffer_load_dwordx4 v[80:83], v63, s[36:39], s8 offen sc1
    buffer_load_dwordx4 v[84:87], v63, s[36:39], s9 offen sc1
    s_add_u32 s24, s24, 1
    s_cmp_eq_u32 s24, 16
    s_cselect_b32 s60, s26, s27
    s_add_u32 s8, s8, s60
    s_add_u32 s9, s9, s60
    buffer_load_dwordx4 v[88:91], v63, s[36:39], s8 offen sc1
    buffer_load_dwordx4 v[92:95], v63, s[36:39], s9 offen sc1
    s_add_u32 s24, s24, 1
    s_cmp_eq_u32 s24, 16
    s_cselect_b32 s60, s26, s27
    s_add_u32 s8, s8, s60
    s_add_u32 s9, s9, s60
    buffer_load_dwordx4 v[96:99], v63, s[36:39], s8 offen sc1
    buffer_load_dwordx4 v[100:103], v63, s[36:39], s9 offen sc1
    s_add_u32 s24, s24, 1
    s_cmp_eq_u32 s24, 16
    s_cselect_b32 s60, s26, s27
    s_add_u32 s8, s8, s60
    s_add_u32 s9, s9, s60
    buffer_load_dwordx4 v[104:107], v63, s[36:39], s8 offen sc1
    buffer_load_dwordx4 v[108:111], v63, s[36:39], s9 offen sc1
    s_add_u32 s24, s24, 1
    s_cmp_eq_u32 s24, 16
    s_cselect_b32 s60, s26, s27
    s_add_u32 s8, s8, s60
    s_add_u32 s9, s9, s60
    buffer_load_dwordx4 v[112:115], v63, s[36:39], s8 offen sc1
    buffer_load_dwordx4 v[116:119], v63, s[36:39], s9 offen sc1
    s_add_u32 s24, s24, 1
    s_cmp_eq_u32 s24, 16
    s_cselect_b32 s60, s26, s27
    s_add_u32 s8, s8, s60
    s_add_u32 s9, s9, s60
    ds_read_b64_tr_b16 v[16:17], v4 offset:8192
    ds_read_b64_tr_b16 v[18:19], v4 offset:9216
    ds_read_b64_tr_b16 v[20:21], v5 offset:8192
    ds_read_b64_tr_b16 v[22:23], v5 offset:9216
    s_waitcnt lgkmcnt(4)
    v_mfma_f32_32x32x16_bf16 v[160:175], v[24:27], v[152:155], v[160:175]
    v_mfma_f32_32x32x16_bf16 v[176:191], v[28:31], v[152:155], v[176:191]
    v_mfma_f32_32x32x16_bf16 v[192:207], v[24:27], v[156:159], v[192:207]
    v_mfma_f32_32x32x16_bf16 v[208:223], v[28:31], v[156:159], v[208:223]
    s_add_u32 m0, s4, 0
    s_add_u32 s25, s25, 1
    buffer_load_dwordx4 v62, s[40:43], s3 offen lds
    s_add_u32 m0, s4, 1024
    s_add_u32 s3, s3, 7168
    buffer_load_dwordx4 v62, s[40:43], s3 offen lds
    s_cmp_eq_u32 s25, 16
    s_cselect_b32 s60, s28, s29
    s_add_u32 s3, s3, s60
    buffer_load_dwordx4 v[120:123], v63, s[36:39], s8 offen sc1
    buffer_load_dwordx4 v[124:127], v63, s[36:39], s9 offen sc1
    s_add_u32 s24, s24, 1
    s_cmp_eq_u32 s24, 16
    s_cselect_b32 s60, s26, s27
    s_add_u32 s8, s8, s60
    s_add_u32 s9, s9, s60
    s_waitcnt vmcnt(22)
    ds_read_b64_tr_b16 v[24:25], v4 offset:10240
    ds_read_b64_tr_b16 v[26:27], v4 offset:11264
    ds_read_b64_tr_b16 v[28:29], v5 offset:10240
    ds_read_b64_tr_b16 v[30:31], v5 offset:11264
    s_waitcnt vmcnt(16)
    s_waitcnt lgkmcnt(4)
    v_mfma_f32_32x32x16_bf16 v[160:175], v[16:19], v[64:67], v[160:175]
    v_mfma_f32_32x32x16_bf16 v[176:191], v[20:23], v[64:67], v[176:191]
    v_mfma_f32_32x32x16_bf16 v[192:207], v[16:19], v[68:71], v[192:207]
    v_mfma_f32_32x32x16_bf16 v[208:223], v[20:23], v[68:71], v[208:223]
    s_add_u32 m0, s4, 2048
    s_add_u32 s25, s25, 1
    buffer_load_dwordx4 v62, s[40:43], s3 offen lds
    s_add_u32 m0, s4, 3072
    s_add_u32 s3, s3, 7168
    buffer_load_dwordx4 v62, s[40:43], s3 offen lds
    s_cmp_eq_u32 s25, 16
    s_cselect_b32 s60, s28, s29
    s_add_u32 s3, s3, s60
    buffer_load_dwordx4 v[128:131], v63, s[36:39], s8 offen sc1
    buffer_load_dwordx4 v[132:135], v63, s[36:39], s9 offen sc1
    s_add_u32 s24, s24, 1
    s_cmp_eq_u32 s24, 16
    s_cselect_b32 s60, s26, s27
    s_add_u32 s8, s8, s60
    s_add_u32 s9, s9, s60
    ds_read_b64_tr_b16 v[16:17], v4 offset:12288
    ds_read_b64_tr_b16 v[18:19], v4 offset:13312
    ds_read_b64_tr_b16 v[20:21], v5 offset:12288
    ds_read_b64_tr_b16 v[22:23], v5 offset:13312
    s_waitcnt vmcnt(18)
    s_waitcnt lgkmcnt(4)
    v_mfma_f32_32x32x16_bf16 v[160:175], v[24:27], v[72:75], v[160:175]
    v_mfma_f32_32x32x16_bf16 v[176:191], v[28:31], v[72:75], v[176:191]
    v_mfma_f32_32x32x16_bf16 v[192:207], v[24:27], v[76:79], v[192:207]
    v_mfma_f32_32x32x16_bf16 v[208:223], v[28:31], v[76:79], v[208:223]
    s_add_u32 m0, s4, 4096
    s_add_u32 s25, s25, 1
    buffer_load_dwordx4 v62, s[40:43], s3 offen lds
    s_add_u32 m0, s4, 5120
    s_add_u32 s3, s3, 7168
    buffer_load_dwordx4 v62, s[40:43], s3 offen lds
    s_cmp_eq_u32 s25, 16
    s_cselect_b32 s60, s28, s29
    s_add_u32 s3, s3, s60
    buffer_load_dwordx4 v[136:139], v63, s[36:39], s8 offen sc1
    buffer_load_dwordx4 v[140:143], v63, s[36:39], s9 offen sc1
    s_add_u32 s24, s24, 1
    s_cmp_eq_u32 s24, 16
    s_cselect_b32 s60, s26, s27
    s_add_u32 s8, s8, s60
    s_add_u32 s9, s9, s60
    ds_read_b64_tr_b16 v[24:25], v4 offset:14336
    ds_read_b64_tr_b16 v[26:27], v4 offset:15360
    ds_read_b64_tr_b16 v[28:29], v5 offset:14336
    ds_read_b64_tr_b16 v[30:31], v5 offset:15360
    s_waitcnt vmcnt(20)
    s_waitcnt lgkmcnt(4)
    v_mfma_f32_32x32x16_bf16 v[160:175], v[16:19], v[80:83], v[160:175]
    v_mfma_f32_32x32x16_bf16 v[176:191], v[20:23], v[80:83], v[176:191]
    v_mfma_f32_32x32x16_bf16 v[192:207], v[16:19], v[84:87], v[192:207]
    v_mfma_f32_32x32x16_bf16 v[208:223], v[20:23], v[84:87], v[208:223]
    s_add_u32 m0, s4, 6144
    s_add_u32 s25, s25, 1
    buffer_load_dwordx4 v62, s[40:43], s3 offen lds
    s_add_u32 m0, s4, 7168
    s_add_u32 s3, s3, 7168
    buffer_load_dwordx4 v62, s[40:43], s3 offen lds
    s_cmp_eq_u32 s25, 16
    s_cselect_b32 s60, s28, s29
    s_add_u32 s3, s3, s60
    buffer_load_dwordx4 v[144:147], v63, s[36:39], s8 offen sc1
    buffer_load_dwordx4 v[148:151], v63, s[36:39], s9 offen sc1
    s_add_u32 s24, s24, 1
    s_cmp_eq_u32 s24, 16
    s_cselect_b32 s60, s26, s27
    s_add_u32 s8, s8, s60
    s_add_u32 s9, s9, s60
    s_waitcnt vmcnt(14)
    ds_read_b64_tr_b16 v[16:17], v4 offset:0
    ds_read_b64_tr_b16 v[18:19], v4 offset:1024
    ds_read_b64_tr_b16 v[20:21], v5 offset:0
    ds_read_b64_tr_b16 v[22:23], v5 offset:1024
    s_waitcnt lgkmcnt(4)
    v_mfma_f32_32x32x16_bf16 v[160:175], v[24:27], v[88:91], v[160:175]
    v_mfma_f32_32x32x16_bf16 v[176:191], v[28:31], v[88:91], v[176:191]
    v_mfma_f32_32x32x16_bf16 v[192:207], v[24:27], v[92:95], v[192:207]
    v_mfma_f32_32x32x16_bf16 v[208:223], v[28:31], v[92:95], v[208:223]
    s_add_u32 m0, s4, 8192
    s_add_u32 s25, s25, 1
    buffer_load_dwordx4 v62, s[40:43], s3 offen lds
    s_add_u32 m0, s4, 9216
    s_add_u32 s3, s3, 7168
    buffer_load_dwordx4 v62, s[40:43], s3 offen lds
    s_cmp_eq_u32 s25, 16
    s_cselect_b32 s60, s28, s29
    s_add_u32 s3, s3, s60
    buffer_load_dwordx4 v[152:155], v63, s[36:39], s8 offen sc1
    buffer_load_dwordx4 v[156:159], v63, s[36:39], s9 offen sc1
    s_add_u32 s24, s24, 1
    s_cmp_eq_u32 s24, 16
    s_cselect_b32 s60, s26, s27
    s_add_u32 s8, s8, s60
    s_add_u32 s9, s9, s60
    s_waitcnt vmcnt(14)
    ds_read_b64_tr_b16 v[24:25], v4 offset:2048
    ds_read_b64_tr_b16 v[26:27], v4 offset:3072
    ds_read_b64_tr_b16 v[28:29], v5 offset:2048
    ds_read_b64_tr_b16 v[30:31], v5 offset:3072
    s_waitcnt lgkmcnt(4)
    v_mfma_f32_32x32x16_bf16 v[160:175], v[16:19], v[96:99], v[160:175]
    v_mfma_f32_32x32x16_bf16 v[176:191], v[20:23], v[96:99], v[176:191]
    v_mfma_f32_32x32x16_bf16 v[192:207], v[16:19], v[100:103], v[192:207]
    v_mfma_f32_32x32x16_bf16 v[208:223], v[20:23], v[100:103], v[208:223]
    s_add_u32 m0, s4, 10240
    s_add_u32 s25, s25, 1
    buffer_load_dwordx4 v62, s[40:43], s3 offen lds
    s_add_u32 m0, s4, 11264
    s_add_u32 s3, s3, 7168
    buffer_load_dwordx4 v62, s[40:43], s3 offen lds
    s_cmp_eq_u32 s25, 16
    s_cselect_b32 s60, s28, s29
    s_add_u32 s3, s3, s60
    buffer_load_dwordx4 v[64:67], v63, s[36:39], s8 offen sc1
    buffer_load_dwordx4 v[68:71], v63, s[36:39], s9 offen sc1
    s_add_u32 s24, s24, 1
    s_cmp_eq_u32 s24, 16
    s_cselect_b32 s60, s26, s27
    s_add_u32 s8, s8, s60
    s_add_u32 s9, s9, s60
    s_waitcnt vmcnt(14)
    ds_read_b64_tr_b16 v[16:17], v4 offset:4096
    ds_read_b64_tr_b16 v[18:19], v4 offset:5120
    ds_read_b64_tr_b16 v[20:21], v5 offset:4096
    ds_read_b64_tr_b16 v[22:23], v5 offset:5120
    s_waitcnt lgkmcnt(4)
    v_mfma_f32_32x32x16_bf16 v[160:175], v[24:27], v[104:107], v[160:175]
    v_mfma_f32_32x32x16_bf16 v[176:191], v[28:31], v[104:107], v[176:191]
    v_mfma_f32_32x32x16_bf16 v[192:207], v[24:27], v[108:111], v[192:207]
    v_mfma_f32_32x32x16_bf16 v[208:223], v[28:31], v[108:111], v[208:223]
    s_add_u32 m0, s4, 12288
    s_add_u32 s25, s25, 1
    buffer_load_dwordx4 v62, s[40:43], s3 offen lds
    s_add_u32 m0, s4, 13312
    s_add_u32 s3, s3, 7168
    buffer_load_dwordx4 v62, s[40:43], s3 offen lds
    s_cmp_eq_u32 s25, 16
    s_cselect_b32 s60, s28, s29
    s_add_u32 s3, s3, s60
    buffer_load_dwordx4 v[72:75], v63, s[36:39], s8 offen sc1
    buffer_load_dwordx4 v[76:79], v63, s[36:39], s9 offen sc1
    s_add_u32 s24, s24, 1
    s_cmp_eq_u32 s24, 16
    s_cselect_b32 s60, s26, s27
    s_add_u32 s8, s8, s60
    s_add_u32 s9, s9, s60
    s_waitcnt vmcnt(14)
    ds_read_b64_tr_b16 v[24:25], v4 offset:6144
    ds_read_b64_tr_b16 v[26:27], v4 offset:7168
    ds_read_b64_tr_b16 v[28:29], v5 offset:6144
    ds_read_b64_tr_b16 v[30:31], v5 offset:7168
    s_waitcnt lgkmcnt(4)
    v_mfma_f32_32x32x16_bf16 v[160:175], v[16:19], v[112:115], v[160:175]
    v_mfma_f32_32x32x16_bf16 v[176:191], v[20:23], v[112:115], v[176:191]
    v_mfma_f32_32x32x16_bf16 v[192:207], v[16:19], v[116:119], v[192:207]
    v_mfma_f32_32x32x16_bf16 v[208:223], v[20:23], v[116:119], v[208:223]
    s_add_u32 m0, s4, 14336
    s_add_u32 s25, s25, 1
    buffer_load_dwordx4 v62, s[40:43], s3 offen lds
    s_add_u32 m0, s4, 15360
    s_add_u32 s3, s3, 7168
    buffer_load_dwordx4 v62, s[40:43], s3 offen lds
    s_cmp_eq_u32 s25, 16
    s_cselect_b32 s60, s28, s29
    s_add_u32 s3, s3, s60
    buffer_load_dwordx4 v[80:83], v63, s[36:39], s8 offen sc1
    buffer_load_dwordx4 v[84:87], v63, s[36:39], s9 offen sc1
    s_add_u32 s24, s24, 1
    s_cmp_eq_u32 s24, 16
    s_cselect_b32 s60, s26, s27
    s_add_u32 s8, s8, s60
    s_add_u32 s9, s9, s60
    s_waitcnt vmcnt(14)
    ds_read_b64_tr_b16 v[16:17], v4 offset:8192
    ds_read_b64_tr_b16 v[18:19], v4 offset:9216
    ds_read_b64_tr_b16 v[20:21], v5 offset:8192
    ds_read_b64_tr_b16 v[22:23], v5 offset:9216
    s_waitcnt lgkmcnt(4)
    v_mfma_f32_32x32x16_bf16 v[160:175], v[24:27], v[120:123], v[160:175]
    v_mfma_f32_32x32x16_bf16 v[176:191], v[28:31], v[120:123], v[176:191]
    v_mfma_f32_32x32x16_bf16 v[192:207], v[24:27], v[124:127], v[192:207]
    v_mfma_f32_32x32x16_bf16 v[208:223], v[28:31], v[124:127], v[208:223]
    s_add_u32 m0, s4, 0
    s_add_u32 s25, s25, 1
    buffer_load_dwordx4 v62, s[40:43], s3 offen lds
    s_add_u32 m0, s4, 1024
    s_add_u32 s3, s3, 7168
    buffer_load_dwordx4 v62, s[40:43], s3 offen lds
    s_cmp_eq_u32 s25, 16
    s_cselect_b32 s60, s28, s29
    s_add_u32 s3, s3, s60
    buffer_load_dwordx4 v[88:91], v63, s[36:39], s8 offen sc1
    buffer_load_dwordx4 v[92:95], v63, s[36:39], s9 offen sc1
    s_add_u32 s24, s24, 1
    s_cmp_eq_u32 s24, 16
    s_cselect_b32 s60, s26, s27
    s_add_u32 s8, s8, s60
    s_add_u32 s9, s9, s60
    s_waitcnt vmcnt(14)
    ds_read_b64_tr_b16 v[24:25], v4 offset:10240
    ds_read_b64_tr_b16 v[26:27], v4 offset:11264
    ds_read_b64_tr_b16 v[28:29], v5 offset:10240
    ds_read_b64_tr_b16 v[30:31], v5 offset:11264
    s_waitcnt lgkmcnt(4)
    v_mfma_f32_32x32x16_bf16 v[160:175], v[16:19], v[128:131], v[160:175]
    v_mfma_f32_32x32x16_bf16 v[176:191], v[20:23], v[128:131], v[176:191]
    v_mfma_f32_32x32x16_bf16 v[192:207], v[16:19], v[132:135], v[192:207]
    v_mfma_f32_32x32x16_bf16 v[208:223], v[20:23], v[132:135], v[208:223]
    s_add_u32 m0, s4, 2048
    s_add_u32 s25, s25, 1
    buffer_load_dwordx4 v62, s[40:43], s3 offen lds
    s_add_u32 m0, s4, 3072
    s_add_u32 s3, s3, 7168
    buffer_load_dwordx4 v62, s[40:43], s3 offen lds
    s_cmp_eq_u32 s25, 16
    s_cselect_b32 s60, s28, s29
    s_add_u32 s3, s3, s60
    s_waitcnt vmcnt(12)
    ds_read_b64_tr_b16 v[16:17], v4 offset:12288
    ds_read_b64_tr_b16 v[18:19], v4 offset:13312
    ds_read_b64_tr_b16 v[20:21], v5 offset:12288
    ds_read_b64_tr_b16 v[22:23], v5 offset:13312
    s_waitcnt lgkmcnt(4)
    v_mfma_f32_32x32x16_bf16 v[160:175], v[24:27], v[136:139], v[160:175]
    v_mfma_f32_32x32x16_bf16 v[176:191], v[28:31], v[136:139], v[176:191]
    v_mfma_f32_32x32x16_bf16 v[192:207], v[24:27], v[140:143], v[192:207]
    v_mfma_f32_32x32x16_bf16 v[208:223], v[28:31], v[140:143], v[208:223]
    s_add_u32 m0, s4, 4096
    s_add_u32 s25, s25, 1
    buffer_load_dwordx4 v62, s[40:43], s3 offen lds
    s_add_u32 m0, s4, 5120
    s_add_u32 s3, s3, 7168
    buffer_load_dwordx4 v62, s[40:43], s3 offen lds
    s_cmp_eq_u32 s25, 16
    s_cselect_b32 s60, s28, s29
    s_add_u32 s3, s3, s60
    s_waitcnt vmcnt(10)
    ds_read_b64_tr_b16 v[24:25], v4 offset:14336
    ds_read_b64_tr_b16 v[26:27], v4 offset:15360
    ds_read_b64_tr_b16 v[28:29], v5 offset:14336
    ds_read_b64_tr_b16 v[30:31], v5 offset:15360
    s_waitcnt lgkmcnt(4)
    v_mfma_f32_32x32x16_bf16 v[160:175], v[16:19], v[144:147], v[160:175]
    v_mfma_f32_32x32x16_bf16 v[176:191], v[20:23], v[144:147], v[176:191]
    v_mfma_f32_32x32x16_bf16 v[192:207], v[16:19], v[148:151], v[192:207]
    v_mfma_f32_32x32x16_bf16 v[208:223], v[20:23], v[148:151], v[208:223]
    s_add_u32 m0, s4, 6144
    s_add_u32 s25, s25, 1
    buffer_load_dwordx4 v62, s[40:43], s3 offen lds
    s_add_u32 m0, s4, 7168
    s_add_u32 s3, s3, 7168
    buffer_load_dwordx4 v62, s[40:43], s3 offen lds
    s_cmp_eq_u32 s25, 16
    s_cselect_b32 s60, s28, s29
    s_add_u32 s3, s3, s60
    s_waitcnt vmcnt(8)
    ds_read_b64_tr_b16 v[16:17], v4 offset:0
    ds_read_b64_tr_b16 v[18:19], v4 offset:1024
    ds_read_b64_tr_b16 v[20:21], v5 offset:0
    ds_read_b64_tr_b16 v[22:23], v5 offset:1024
    s_waitcnt lgkmcnt(4)
    v_mfma_f32_32x32x16_bf16 v[160:175], v[24:27], v[152:155], v[160:175]
    v_mfma_f32_32x32x16_bf16 v[176:191], v[28:31], v[152:155], v[176:191]
    v_mfma_f32_32x32x16_bf16 v[192:207], v[24:27], v[156:159], v[192:207]
    v_mfma_f32_32x32x16_bf16 v[208:223], v[28:31], v[156:159], v[208:223]
    s_mul_i32 s3, s66, 100352
    s_lshl_b32 s60, s14, 7
    s_add_u32 s3, s3, s60
    v_lshrrev_b32 v41, 3, v1
    v_add_u32 v41, 1, v41
    v_lshrrev_b32 v41, 2, v41
    v_mul_u32_u24 v41, 896, v41
    v_sub_u32 v42, v62, v41
    s_add_u32 m0, s4, 8192
    s_nop 0
    buffer_load_dwordx4 v62, s[44:47], s3 offen lds
    s_add_u32 m0, s4, 9216
    s_add_u32 s3, s3, 7168
    buffer_load_dwordx4 v42, s[44:47], s3 offen lds
    s_add_u32 s3, s3, 5376
    s_waitcnt vmcnt(6)
    ds_read_b64_tr_b16 v[24:25], v4 offset:2048
    ds_read_b64_tr_b16 v[26:27], v4 offset:3072
    ds_read_b64_tr_b16 v[28:29], v5 offset:2048
    ds_read_b64_tr_b16 v[30:31], v5 offset:3072
    s_waitcnt lgkmcnt(4)
    v_mfma_f32_32x32x16_bf16 v[160:175], v[16:19], v[64:67], v[160:175]
    v_mfma_f32_32x32x16_bf16 v[176:191], v[20:23], v[64:67], v[176:191]
    v_mfma_f32_32x32x16_bf16 v[192:207], v[16:19], v[68:71], v[192:207]
    v_mfma_f32_32x32x16_bf16 v[208:223], v[20:23], v[68:71], v[208:223]
    s_add_u32 m0, s4, 10240
    s_nop 0
    buffer_load_dwordx4 v62, s[44:47], s3 offen lds
    s_add_u32 m0, s4, 11264
    s_add_u32 s3, s3, 7168
    buffer_load_dwordx4 v42, s[44:47], s3 offen lds
    s_add_u32 s3, s3, 5376
    s_waitcnt vmcnt(6)
    ds_read_b64_tr_b16 v[16:17], v4 offset:4096
    ds_read_b64_tr_b16 v[18:19], v4 offset:5120
    ds_read_b64_tr_b16 v[20:21], v5 offset:4096
    ds_read_b64_tr_b16 v[22:23], v5 offset:5120
    s_waitcnt lgkmcnt(4)
    v_mfma_f32_32x32x16_bf16 v[160:175], v[24:27], v[72:75], v[160:175]
    v_mfma_f32_32x32x16_bf16 v[176:191], v[28:31], v[72:75], v[176:191]
    v_mfma_f32_32x32x16_bf16 v[192:207], v[24:27], v[76:79], v[192:207]
    v_mfma_f32_32x32x16_bf16 v[208:223], v[28:31], v[76:79], v[208:223]
    s_add_u32 m0, s4, 12288
    s_nop 0
    buffer_load_dwordx4 v62, s[44:47], s3 offen lds
    s_add_u32 m0, s4, 13312
    s_add_u32 s3, s3, 7168
    buffer_load_dwordx4 v42, s[44:47], s3 offen lds
    s_add_u32 s3, s3, 5376
    s_waitcnt vmcnt(6)
    ds_read_b64_tr_b16 v[24:25], v4 offset:6144
    ds_read_b64_tr_b16 v[26:27], v4 offset:7168
    ds_read_b64_tr_b16 v[28:29], v5 offset:6144
    ds_read_b64_tr_b16 v[30:31], v5 offset:7168
    s_waitcnt lgkmcnt(4)
    v_mfma_f32_32x32x16_bf16 v[160:175], v[16:19], v[80:83], v[160:175]
    v_mfma_f32_32x32x16_bf16 v[176:191], v[20:23], v[80:83], v[176:191]
    v_mfma_f32_32x32x16_bf16 v[192:207], v[16:19], v[84:87], v[192:207]
    v_mfma_f32_32x32x16_bf16 v[208:223], v[20:23], v[84:87], v[208:223]
    s_add_u32 m0, s4, 14336
    s_nop 0
    buffer_load_dwordx4 v62, s[44:47], s3 offen lds
    s_add_u32 m0, s4, 15360
    s_add_u32 s3, s3, 7168
    buffer_load_dwordx4 v42, s[44:47], s3 offen lds
    s_add_u32 s3, s3, 5376
    s_waitcnt lgkmcnt(0)
    v_mfma_f32_32x32x16_bf16 v[160:175], v[24:27], v[88:91], v[160:175]
    v_mfma_f32_32x32x16_bf16 v[176:191], v[28:31], v[88:91], v[176:191]
    v_mfma_f32_32x32x16_bf16 v[192:207], v[24:27], v[92:95], v[192:207]
    v_mfma_f32_32x32x16_bf16 v[208:223], v[28:31], v[92:95], v[208:223]
    s_add_u32 m0, s4, 0
    s_nop 0
    buffer_load_dwordx4 v62, s[44:47], s3 offen lds
    s_add_u32 m0, s4, 1024
    s_add_u32 s3, s3, 7168
    buffer_load_dwordx4 v42, s[44:47], s3 offen lds
    s_add_u32 s3, s3, 5376
    s_add_u32 m0, s4, 2048
    s_nop 0
    buffer_load_dwordx4 v62, s[44:47], s3 offen lds
    s_add_u32 m0, s4, 3072
    s_add_u32 s3, s3, 7168
    buffer_load_dwordx4 v42, s[44:47], s3 offen lds
    s_add_u32 s3, s3, 5376
    s_add_u32 m0, s4, 4096
    s_nop 0
    buffer_load_dwordx4 v62, s[44:47], s3 offen lds
    s_add_u32 m0, s4, 5120
    s_add_u32 s3, s3, 7168
    buffer_load_dwordx4 v42, s[44:47], s3 offen lds
    s_add_u32 s3, s3, 5376
    s_add_u32 m0, s4, 6144
    s_nop 0
    buffer_load_dwordx4 v62, s[44:47], s3 offen lds
    s_add_u32 m0, s4, 7168
    s_add_u32 s3, s3, 7168
    buffer_load_dwordx4 v42, s[44:47], s3 offen lds
    s_add_u32 s3, s3, 5376
    s_lshl_b32 s60, s13, 6
    s_lshl_b32 s61, s66, 4
    s_add_u32 s60, s60, s61
    s_mul_i32 s60, s60, 896
    s_lshl_b32 s61, s14, 7
    s_add_u32 s64, s60, s61
    s_add_u32 s65, s64, 7168
    buffer_load_dwordx4 v[240:243], v40, s[32:35], s64 offen
    buffer_load_dwordx4 v[244:247], v40, s[32:35], s65 offen
    v_and_b32 v36, 3, v1
    v_bfe_u32 v33, v1, 2, 1
    v_lshl_add_u32 v36, v33, 4, v36
    v_lshlrev_b32 v36, 2, v36
    s_mov_b32 s63, 0x10000
    s_lshl_b32 s8, s13, 16
    s_lshl_b32 s60, s66, 13
    s_add_u32 s8, s8, s60
    s_add_u32 s8, s8, 9707520
    s_add_u32 s9, s8, 32768
    s_waitcnt vmcnt(2)
    ds_read_b64_tr_b16 v[64:65], v4 offset:8192
    ds_read_b64_tr_b16 v[66:67], v4 offset:9216
    ds_read_b64_tr_b16 v[68:69], v5 offset:8192
    ds_read_b64_tr_b16 v[70:71], v5 offset:9216
    ds_read_b64_tr_b16 v[72:73], v4 offset:10240
    ds_read_b64_tr_b16 v[74:75], v4 offset:11264
    ds_read_b64_tr_b16 v[76:77], v5 offset:10240
    ds_read_b64_tr_b16 v[78:79], v5 offset:11264
    ds_read_b64_tr_b16 v[80:81], v4 offset:12288
    ds_read_b64_tr_b16 v[82:83], v4 offset:13312
    ds_read_b64_tr_b16 v[84:85], v5 offset:12288
    ds_read_b64_tr_b16 v[86:87], v5 offset:13312
    ds_read_b64_tr_b16 v[88:89], v4 offset:14336
    ds_read_b64_tr_b16 v[90:91], v4 offset:15360
    ds_read_b64_tr_b16 v[92:93], v5 offset:14336
    ds_read_b64_tr_b16 v[94:95], v5 offset:15360
    ds_read_b64_tr_b16 v[96:97], v4 offset:0
    ds_read_b64_tr_b16 v[98:99], v4 offset:1024
    ds_read_b64_tr_b16 v[100:101], v5 offset:0
    ds_read_b64_tr_b16 v[102:103], v5 offset:1024
    ds_read_b64_tr_b16 v[104:105], v4 offset:2048
    ds_read_b64_tr_b16 v[106:107], v4 offset:3072
    ds_read_b64_tr_b16 v[108:109], v5 offset:2048
    ds_read_b64_tr_b16 v[110:111], v5 offset:3072
    ds_read_b64_tr_b16 v[112:113], v4 offset:4096
    ds_read_b64_tr_b16 v[114:115], v4 offset:5120
    ds_read_b64_tr_b16 v[116:117], v5 offset:4096
    ds_read_b64_tr_b16 v[118:119], v5 offset:5120
    ds_read_b64_tr_b16 v[120:121], v4 offset:6144
    ds_read_b64_tr_b16 v[122:123], v4 offset:7168
    ds_read_b64_tr_b16 v[124:125], v5 offset:6144
    ds_read_b64_tr_b16 v[126:127], v5 offset:7168
    s_waitcnt lgkmcnt(0)
    v_and_b32 v32, 31, v1
    v_mul_u32_u24 v32, 272, v32
    v_lshrrev_b32 v33, 5, v1
    v_lshl_add_u32 v32, v33, 4, v32
    s_sub_u32 s60, s4, 1024
    v_add_u32 v32, s60, v32
    s_nop 7
    ds_write_b128 v32, v[160:163] offset:0
    ds_write_b128 v32, v[164:167] offset:32
    ds_write_b128 v32, v[168:171] offset:64
    ds_write_b128 v32, v[172:175] offset:96
    ds_write_b128 v32, v[176:179] offset:128
    ds_write_b128 v32, v[180:183] offset:160
    ds_write_b128 v32, v[184:187] offset:192
    ds_write_b128 v32, v[188:191] offset:224
    ds_write_b128 v32, v[192:195] offset:8704
    ds_write_b128 v32, v[196:199] offset:8736
    ds_write_b128 v32, v[200:203] offset:8768
    ds_write_b128 v32, v[204:207] offset:8800
    ds_write_b128 v32, v[208:211] offset:8832
    ds_write_b128 v32, v[212:215] offset:8864
    ds_write_b128 v32, v[216:219] offset:8896
    ds_write_b128 v32, v[220:223] offset:8928
    s_waitcnt lgkmcnt(0)
    s_barrier
    s_add_u32 s24, s8, 4096
    s_add_u32 s25, s9, 4096
    v_lshrrev_b32 v32, 3, v1
    v_mul_u32_u24 v32, 272, v32
    v_and_b32 v33, 7, v1
    v_lshl_add_u32 v32, v33, 5, v32
    s_mul_i32 s60, s66, 4352
    s_add_u32 s60, s60, 16384
    v_add_u32 v32, s60, v32
    v_add_u32 v33, 67584, v32
    ds_read_b128 v[160:163], v32 offset:0
    ds_read_b128 v[164:167], v32 offset:16
    ds_read_b128 v[168:171], v32 offset:33792
    ds_read_b128 v[172:175], v32 offset:33808
    ds_read_b128 v[176:179], v33 offset:0
    ds_read_b128 v[180:183], v33 offset:16
    ds_read_b128 v[184:187], v33 offset:33792
    ds_read_b128 v[188:191], v33 offset:33808
    ds_read_b128 v[192:195], v32 offset:2176
    ds_read_b128 v[196:199], v32 offset:2192
    ds_read_b128 v[200:203], v32 offset:35968
    ds_read_b128 v[204:207], v32 offset:35984
    ds_read_b128 v[208:211], v33 offset:2176
    ds_read_b128 v[212:215], v33 offset:2192
    ds_read_b128 v[216:219], v33 offset:35968
    ds_read_b128 v[220:223], v33 offset:35984
    s_waitcnt lgkmcnt(8)
    v_add_f32 v160, v160, v168
    v_add_f32 v176, v176, v184
    v_add_f32 v161, v161, v169
    v_add_f32 v177, v177, v185
    v_add_f32 v162, v162, v170
    v_add_f32 v178, v178, v186
    v_add_f32 v163, v163, v171
    v_add_f32 v179, v179, v187
    v_add_f32 v164, v164, v172
    v_add_f32 v180, v180, v188
    v_add_f32 v165, v165, v173
    v_add_f32 v181, v181, v189
    v_add_f32 v166, v166, v174
    v_add_f32 v182, v182, v190
    v_add_f32 v167, v167, v175
    v_add_f32 v183, v183, v191
    v_add_f32 v160, v160, v176
    v_add_f32 v161, v161, v177
    v_add_f32 v162, v162, v178
    v_add_f32 v163, v163, v179
    v_add_f32 v164, v164, v180
    v_add_f32 v165, v165, v181
    v_add_f32 v166, v166, v182
    v_add_f32 v167, v167, v183
    s_waitcnt lgkmcnt(0)
    v_add_f32 v192, v192, v200
    v_add_f32 v208, v208, v216
    v_add_f32 v193, v193, v201
    v_add_f32 v209, v209, v217
    v_add_f32 v194, v194, v202
    v_add_f32 v210, v210, v218
    v_add_f32 v195, v195, v203
    v_add_f32 v211, v211, v219
    v_add_f32 v196, v196, v204
    v_add_f32 v212, v212, v220
    v_add_f32 v197, v197, v205
    v_add_f32 v213, v213, v221
    v_add_f32 v198, v198, v206
    v_add_f32 v214, v214, v222
    v_add_f32 v199, v199, v207
    v_add_f32 v215, v215, v223
    v_add_f32 v192, v192, v208
    v_add_f32 v193, v193, v209
    v_add_f32 v194, v194, v210
    v_add_f32 v195, v195, v211
    v_add_f32 v196, v196, v212
    v_add_f32 v197, v197, v213
    v_add_f32 v198, v198, v214
    v_add_f32 v199, v199, v215
    s_mov_b32 s62, 0xbfb8aa3b
    v_mul_f32 v160, v160, v38
    v_mul_f32 v161, v161, v38
    v_mul_f32 v162, v162, v38
    v_mul_f32 v163, v163, v38
    v_mul_f32 v164, v164, v38
    v_mul_f32 v165, v165, v38
    v_mul_f32 v166, v166, v38
    v_mul_f32 v167, v167, v38
    v_mul_f32 v168, s62, v160
    v_mul_f32 v169, s62, v161
    v_mul_f32 v170, s62, v162
    v_mul_f32 v171, s62, v163
    v_mul_f32 v172, s62, v164
    v_mul_f32 v173, s62, v165
    v_mul_f32 v174, s62, v166
    v_mul_f32 v175, s62, v167
    v_exp_f32 v168, v168
    v_exp_f32 v169, v169
    v_exp_f32 v170, v170
    v_exp_f32 v171, v171
    v_exp_f32 v172, v172
    v_exp_f32 v173, v173
    v_exp_f32 v174, v174
    v_exp_f32 v175, v175
    v_add_f32 v168, 1.0, v168
    v_add_f32 v169, 1.0, v169
    v_add_f32 v170, 1.0, v170
    v_add_f32 v171, 1.0, v171
    v_add_f32 v172, 1.0, v172
    v_add_f32 v173, 1.0, v173
    v_add_f32 v174, 1.0, v174
    v_add_f32 v175, 1.0, v175
    v_rcp_f32 v168, v168
    v_rcp_f32 v169, v169
    v_rcp_f32 v170, v170
    v_rcp_f32 v171, v171
    v_rcp_f32 v172, v172
    v_rcp_f32 v173, v173
    v_rcp_f32 v174, v174
    v_rcp_f32 v175, v175
    v_mul_f32 v224, v160, v168
    v_mul_f32 v225, v161, v169
    v_mul_f32 v226, v162, v170
    v_mul_f32 v227, v163, v171
    v_mul_f32 v228, v164, v172
    v_mul_f32 v229, v165, v173
    v_mul_f32 v230, v166, v174
    v_mul_f32 v231, v167, v175
    v_mul_f32 v192, v192, v39
    v_mul_f32 v193, v193, v39
    v_mul_f32 v194, v194, v39
    v_mul_f32 v195, v195, v39
    v_mul_f32 v196, v196, v39
    v_mul_f32 v197, v197, v39
    v_mul_f32 v198, v198, v39
    v_mul_f32 v199, v199, v39
    v_mul_f32 v200, s62, v192
    v_mul_f32 v201, s62, v193
    v_mul_f32 v202, s62, v194
    v_mul_f32 v203, s62, v195
    v_mul_f32 v204, s62, v196
    v_mul_f32 v205, s62, v197
    v_mul_f32 v206, s62, v198
    v_mul_f32 v207, s62, v199
    v_exp_f32 v200, v200
    v_exp_f32 v201, v201
    v_exp_f32 v202, v202
    v_exp_f32 v203, v203
    v_exp_f32 v204, v204
    v_exp_f32 v205, v205
    v_exp_f32 v206, v206
    v_exp_f32 v207, v207
    v_add_f32 v200, 1.0, v200
    v_add_f32 v201, 1.0, v201
    v_add_f32 v202, 1.0, v202
    v_add_f32 v203, 1.0, v203
    v_add_f32 v204, 1.0, v204
    v_add_f32 v205, 1.0, v205
    v_add_f32 v206, 1.0, v206
    v_add_f32 v207, 1.0, v207
    v_rcp_f32 v200, v200
    v_rcp_f32 v201, v201
    v_rcp_f32 v202, v202
    v_rcp_f32 v203, v203
    v_rcp_f32 v204, v204
    v_rcp_f32 v205, v205
    v_rcp_f32 v206, v206
    v_rcp_f32 v207, v207
    v_mul_f32 v232, v192, v200
    v_mul_f32 v233, v193, v201
    v_mul_f32 v234, v194, v202
    v_mul_f32 v235, v195, v203
    v_mul_f32 v236, v196, v204
    v_mul_f32 v237, v197, v205
    v_mul_f32 v238, v198, v206
    v_mul_f32 v239, v199, v207
    buffer_load_dwordx4 v[128:131], v63, s[36:39], s8 offen offset:0 sc1
    buffer_load_dwordx4 v[132:135], v63, s[36:39], s9 offen offset:0 sc1
    buffer_load_dwordx4 v[136:139], v63, s[36:39], s8 offen offset:1024 sc1
    buffer_load_dwordx4 v[140:143], v63, s[36:39], s9 offen offset:1024 sc1
    buffer_load_dwordx4 v[144:147], v63, s[36:39], s8 offen offset:2048 sc1
    buffer_load_dwordx4 v[148:151], v63, s[36:39], s9 offen offset:2048 sc1
    buffer_load_dwordx4 v[152:155], v63, s[36:39], s8 offen offset:3072 sc1
    buffer_load_dwordx4 v[156:159], v63, s[36:39], s9 offen offset:3072 sc1
    buffer_load_dwordx4 v[8:11], v63, s[36:39], s24 offen offset:0 sc1
    buffer_load_dwordx4 v[12:15], v63, s[36:39], s25 offen offset:0 sc1
    buffer_load_dwordx4 v[16:19], v63, s[36:39], s24 offen offset:1024 sc1
    buffer_load_dwordx4 v[20:23], v63, s[36:39], s25 offen offset:1024 sc1
    buffer_load_dwordx4 v[24:27], v63, s[36:39], s24 offen offset:2048 sc1
    buffer_load_dwordx4 v[28:31], v63, s[36:39], s25 offen offset:2048 sc1
    buffer_load_dwordx4 v[44:47], v63, s[36:39], s24 offen offset:3072 sc1
    buffer_load_dwordx4 v[48:51], v63, s[36:39], s25 offen offset:3072 sc1
    s_barrier
    s_waitcnt vmcnt(14)
    s_mov_b32 s62, 0
ORT_75:
    v_and_b32 v34, v131, v135
    v_cmp_gt_u32 vcc, s63, v34
    s_add_u32 s62, s62, 1
    s_cbranch_vccz OOK_76
    s_waitcnt vmcnt(0)
    buffer_load_dwordx4 v[128:131], v63, s[36:39], s8 offen offset:0 sc1
    buffer_load_dwordx4 v[132:135], v63, s[36:39], s9 offen offset:0 sc1
    buffer_load_dwordx4 v[136:139], v63, s[36:39], s8 offen offset:1024 sc1
    buffer_load_dwordx4 v[140:143], v63, s[36:39], s9 offen offset:1024 sc1
    buffer_load_dwordx4 v[144:147], v63, s[36:39], s8 offen offset:2048 sc1
    buffer_load_dwordx4 v[148:151], v63, s[36:39], s9 offen offset:2048 sc1
    buffer_load_dwordx4 v[152:155], v63, s[36:39], s8 offen offset:3072 sc1
    buffer_load_dwordx4 v[156:159], v63, s[36:39], s9 offen offset:3072 sc1
    buffer_load_dwordx4 v[8:11], v63, s[36:39], s24 offen offset:0 sc1
    buffer_load_dwordx4 v[12:15], v63, s[36:39], s25 offen offset:0 sc1
    buffer_load_dwordx4 v[16:19], v63, s[36:39], s24 offen offset:1024 sc1
    buffer_load_dwordx4 v[20:23], v63, s[36:39], s25 offen offset:1024 sc1
    buffer_load_dwordx4 v[24:27], v63, s[36:39], s24 offen offset:2048 sc1
    buffer_load_dwordx4 v[28:31], v63, s[36:39], s25 offen offset:2048 sc1
    buffer_load_dwordx4 v[44:47], v63, s[36:39], s24 offen offset:3072 sc1
    buffer_load_dwordx4 v[48:51], v63, s[36:39], s25 offen offset:3072 sc1
    s_waitcnt vmcnt(14)
    s_cmp_lt_u32 s62, 0x100000
    s_cbranch_scc1 ORT_75
OOK_76:
    v_mfma_f32_32x32x16_bf16 v[160:175], v[64:67], v[128:131], 0
    v_mfma_f32_32x32x16_bf16 v[176:191], v[68:71], v[128:131], 0
    v_mfma_f32_32x32x16_bf16 v[192:207], v[64:67], v[132:135], 0
    v_mfma_f32_32x32x16_bf16 v[208:223], v[68:71], v[132:135], 0
    s_waitcnt vmcnt(12)
    s_mov_b32 s62, 0
ORT_77:
    v_and_b32 v34, v139, v143
    v_cmp_gt_u32 vcc, s63, v34
    s_add_u32 s62, s62, 1
    s_cbranch_vccz OOK_78
    s_waitcnt vmcnt(0)
    buffer_load_dwordx4 v[136:139], v63, s[36:39], s8 offen offset:1024 sc1
    buffer_load_dwordx4 v[140:143], v63, s[36:39], s9 offen offset:1024 sc1
    buffer_load_dwordx4 v[144:147], v63, s[36:39], s8 offen offset:2048 sc1
    buffer_load_dwordx4 v[148:151], v63, s[36:39], s9 offen offset:2048 sc1
    buffer_load_dwordx4 v[152:155], v63, s[36:39], s8 offen offset:3072 sc1
    buffer_load_dwordx4 v[156:159], v63, s[36:39], s9 offen offset:3072 sc1
    buffer_load_dwordx4 v[8:11], v63, s[36:39], s24 offen offset:0 sc1
    buffer_load_dwordx4 v[12:15], v63, s[36:39], s25 offen offset:0 sc1
    buffer_load_dwordx4 v[16:19], v63, s[36:39], s24 offen offset:1024 sc1
    buffer_load_dwordx4 v[20:23], v63, s[36:39], s25 offen offset:1024 sc1
    buffer_load_dwordx4 v[24:27], v63, s[36:39], s24 offen offset:2048 sc1
    buffer_load_dwordx4 v[28:31], v63, s[36:39], s25 offen offset:2048 sc1
    buffer_load_dwordx4 v[44:47], v63, s[36:39], s24 offen offset:3072 sc1
    buffer_load_dwordx4 v[48:51], v63, s[36:39], s25 offen offset:3072 sc1
    s_waitcnt vmcnt(12)
    s_cmp_lt_u32 s62, 0x100000
    s_cbranch_scc1 ORT_77
OOK_78:
    v_mfma_f32_32x32x16_bf16 v[160:175], v[72:75], v[136:139], v[160:175]
    v_mfma_f32_32x32x16_bf16 v[176:191], v[76:79], v[136:139], v[176:191]
    v_mfma_f32_32x32x16_bf16 v[192:207], v[72:75], v[140:143], v[192:207]
    v_mfma_f32_32x32x16_bf16 v[208:223], v[76:79], v[140:143], v[208:223]
    s_waitcnt vmcnt(10)
    s_mov_b32 s62, 0
ORT_79:
    v_and_b32 v34, v147, v151
    v_cmp_gt_u32 vcc, s63, v34
    s_add_u32 s62, s62, 1
    s_cbranch_vccz OOK_80
    s_waitcnt vmcnt(0)
    buffer_load_dwordx4 v[144:147], v63, s[36:39], s8 offen offset:2048 sc1
    buffer_load_dwordx4 v[148:151], v63, s[36:39], s9 offen offset:2048 sc1
    buffer_load_dwordx4 v[152:155], v63, s[36:39], s8 offen offset:3072 sc1
    buffer_load_dwordx4 v[156:159], v63, s[36:39], s9 offen offset:3072 sc1
    buffer_load_dwordx4 v[8:11], v63, s[36:39], s24 offen offset:0 sc1
    buffer_load_dwordx4 v[12:15], v63, s[36:39], s25 offen offset:0 sc1
    buffer_load_dwordx4 v[16:19], v63, s[36:39], s24 offen offset:1024 sc1
    buffer_load_dwordx4 v[20:23], v63, s[36:39], s25 offen offset:1024 sc1
    buffer_load_dwordx4 v[24:27], v63, s[36:39], s24 offen offset:2048 sc1
    buffer_load_dwordx4 v[28:31], v63, s[36:39], s25 offen offset:2048 sc1
    buffer_load_dwordx4 v[44:47], v63, s[36:39], s24 offen offset:3072 sc1
    buffer_load_dwordx4 v[48:51], v63, s[36:39], s25 offen offset:3072 sc1
    s_waitcnt vmcnt(10)
    s_cmp_lt_u32 s62, 0x100000
    s_cbranch_scc1 ORT_79
OOK_80:
    v_mfma_f32_32x32x16_bf16 v[160:175], v[80:83], v[144:147], v[160:175]
    v_mfma_f32_32x32x16_bf16 v[176:191], v[84:87], v[144:147], v[176:191]
    v_mfma_f32_32x32x16_bf16 v[192:207], v[80:83], v[148:151], v[192:207]
    v_mfma_f32_32x32x16_bf16 v[208:223], v[84:87], v[148:151], v[208:223]
    s_waitcnt vmcnt(8)
    s_mov_b32 s62, 0
ORT_81:
    v_and_b32 v34, v155, v159
    v_cmp_gt_u32 vcc, s63, v34
    s_add_u32 s62, s62, 1
    s_cbranch_vccz OOK_82
    s_waitcnt vmcnt(0)
    buffer_load_dwordx4 v[152:155], v63, s[36:39], s8 offen offset:3072 sc1
    buffer_load_dwordx4 v[156:159], v63, s[36:39], s9 offen offset:3072 sc1
    buffer_load_dwordx4 v[8:11], v63, s[36:39], s24 offen offset:0 sc1
    buffer_load_dwordx4 v[12:15], v63, s[36:39], s25 offen offset:0 sc1
    buffer_load_dwordx4 v[16:19], v63, s[36:39], s24 offen offset:1024 sc1
    buffer_load_dwordx4 v[20:23], v63, s[36:39], s25 offen offset:1024 sc1
    buffer_load_dwordx4 v[24:27], v63, s[36:39], s24 offen offset:2048 sc1
    buffer_load_dwordx4 v[28:31], v63, s[36:39], s25 offen offset:2048 sc1
    buffer_load_dwordx4 v[44:47], v63, s[36:39], s24 offen offset:3072 sc1
    buffer_load_dwordx4 v[48:51], v63, s[36:39], s25 offen offset:3072 sc1
    s_waitcnt vmcnt(8)
    s_cmp_lt_u32 s62, 0x100000
    s_cbranch_scc1 ORT_81
OOK_82:
    v_mfma_f32_32x32x16_bf16 v[160:175], v[88:91], v[152:155], v[160:175]
    v_mfma_f32_32x32x16_bf16 v[176:191], v[92:95], v[152:155], v[176:191]
    v_mfma_f32_32x32x16_bf16 v[192:207], v[88:91], v[156:159], v[192:207]
    v_mfma_f32_32x32x16_bf16 v[208:223], v[92:95], v[156:159], v[208:223]
    s_waitcnt vmcnt(6)
    s_mov_b32 s62, 0
ORT_83:
    v_and_b32 v34, v11, v15
    v_cmp_gt_u32 vcc, s63, v34
    s_add_u32 s62, s62, 1
    s_cbranch_vccz OOK_84
    s_waitcnt vmcnt(0)
    buffer_load_dwordx4 v[8:11], v63, s[36:39], s24 offen offset:0 sc1
    buffer_load_dwordx4 v[12:15], v63, s[36:39], s25 offen offset:0 sc1
    buffer_load_dwordx4 v[16:19], v63, s[36:39], s24 offen offset:1024 sc1
    buffer_load_dwordx4 v[20:23], v63, s[36:39], s25 offen offset:1024 sc1
    buffer_load_dwordx4 v[24:27], v63, s[36:39], s24 offen offset:2048 sc1
    buffer_load_dwordx4 v[28:31], v63, s[36:39], s25 offen offset:2048 sc1
    buffer_load_dwordx4 v[44:47], v63, s[36:39], s24 offen offset:3072 sc1
    buffer_load_dwordx4 v[48:51], v63, s[36:39], s25 offen offset:3072 sc1
    s_waitcnt vmcnt(6)
    s_cmp_lt_u32 s62, 0x100000
    s_cbranch_scc1 ORT_83
OOK_84:
    v_mfma_f32_32x32x16_bf16 v[160:175], v[96:99], v[8:11], v[160:175]
    v_mfma_f32_32x32x16_bf16 v[176:191], v[100:103], v[8:11], v[176:191]
    v_mfma_f32_32x32x16_bf16 v[192:207], v[96:99], v[12:15], v[192:207]
    v_mfma_f32_32x32x16_bf16 v[208:223], v[100:103], v[12:15], v[208:223]
    s_waitcnt vmcnt(4)
    s_mov_b32 s62, 0
ORT_85:
    v_and_b32 v34, v19, v23
    v_cmp_gt_u32 vcc, s63, v34
    s_add_u32 s62, s62, 1
    s_cbranch_vccz OOK_86
    s_waitcnt vmcnt(0)
    buffer_load_dwordx4 v[16:19], v63, s[36:39], s24 offen offset:1024 sc1
    buffer_load_dwordx4 v[20:23], v63, s[36:39], s25 offen offset:1024 sc1
    buffer_load_dwordx4 v[24:27], v63, s[36:39], s24 offen offset:2048 sc1
    buffer_load_dwordx4 v[28:31], v63, s[36:39], s25 offen offset:2048 sc1
    buffer_load_dwordx4 v[44:47], v63, s[36:39], s24 offen offset:3072 sc1
    buffer_load_dwordx4 v[48:51], v63, s[36:39], s25 offen offset:3072 sc1
    s_waitcnt vmcnt(4)
    s_cmp_lt_u32 s62, 0x100000
    s_cbranch_scc1 ORT_85
OOK_86:
    v_mfma_f32_32x32x16_bf16 v[160:175], v[104:107], v[16:19], v[160:175]
    v_mfma_f32_32x32x16_bf16 v[176:191], v[108:111], v[16:19], v[176:191]
    v_mfma_f32_32x32x16_bf16 v[192:207], v[104:107], v[20:23], v[192:207]
    v_mfma_f32_32x32x16_bf16 v[208:223], v[108:111], v[20:23], v[208:223]
    s_waitcnt vmcnt(2)
    s_mov_b32 s62, 0
ORT_87:
    v_and_b32 v34, v27, v31
    v_cmp_gt_u32 vcc, s63, v34
    s_add_u32 s62, s62, 1
    s_cbranch_vccz OOK_88
    s_waitcnt vmcnt(0)
    buffer_load_dwordx4 v[24:27], v63, s[36:39], s24 offen offset:2048 sc1
    buffer_load_dwordx4 v[28:31], v63, s[36:39], s25 offen offset:2048 sc1
    buffer_load_dwordx4 v[44:47], v63, s[36:39], s24 offen offset:3072 sc1
    buffer_load_dwordx4 v[48:51], v63, s[36:39], s25 offen offset:3072 sc1
    s_waitcnt vmcnt(2)
    s_cmp_lt_u32 s62, 0x100000
    s_cbranch_scc1 ORT_87
OOK_88:
    v_mfma_f32_32x32x16_bf16 v[160:175], v[112:115], v[24:27], v[160:175]
    v_mfma_f32_32x32x16_bf16 v[176:191], v[116:119], v[24:27], v[176:191]
    v_mfma_f32_32x32x16_bf16 v[192:207], v[112:115], v[28:31], v[192:207]
    v_mfma_f32_32x32x16_bf16 v[208:223], v[116:119], v[28:31], v[208:223]
    s_waitcnt vmcnt(0)
    s_mov_b32 s62, 0
ORT_89:
    v_and_b32 v34, v47, v51
    v_cmp_gt_u32 vcc, s63, v34
    s_add_u32 s62, s62, 1
    s_cbranch_vccz OOK_90
    s_waitcnt vmcnt(0)
    buffer_load_dwordx4 v[44:47], v63, s[36:39], s24 offen offset:3072 sc1
    buffer_load_dwordx4 v[48:51], v63, s[36:39], s25 offen offset:3072 sc1
    s_waitcnt vmcnt(0)
    s_cmp_lt_u32 s62, 0x100000
    s_cbranch_scc1 ORT_89
OOK_90:
    v_mfma_f32_32x32x16_bf16 v[160:175], v[120:123], v[44:47], v[160:175]
    v_mfma_f32_32x32x16_bf16 v[176:191], v[124:127], v[44:47], v[176:191]
    v_mfma_f32_32x32x16_bf16 v[192:207], v[120:123], v[48:51], v[192:207]
    v_mfma_f32_32x32x16_bf16 v[208:223], v[124:127], v[48:51], v[208:223]
    v_and_b32 v32, 31, v1
    v_mul_u32_u24 v32, 272, v32
    v_lshrrev_b32 v33, 5, v1
    v_lshl_add_u32 v32, v33, 4, v32
    s_sub_u32 s60, s4, 1024
    v_add_u32 v32, s60, v32
    s_nop 7
    ds_write_b128 v32, v[160:163] offset:0
    ds_write_b128 v32, v[164:167] offset:32
    ds_write_b128 v32, v[168:171] offset:64
    ds_write_b128 v32, v[172:175] offset:96
    ds_write_b128 v32, v[176:179] offset:128
    ds_write_b128 v32, v[180:183] offset:160
    ds_write_b128 v32, v[184:187] offset:192
    ds_write_b128 v32, v[188:191] offset:224
    ds_write_b128 v32, v[192:195] offset:8704
    ds_write_b128 v32, v[196:199] offset:8736
    ds_write_b128 v32, v[200:203] offset:8768
    ds_write_b128 v32, v[204:207] offset:8800
    ds_write_b128 v32, v[208:211] offset:8832
    ds_write_b128 v32, v[212:215] offset:8864
    ds_write_b128 v32, v[216:219] offset:8896
    ds_write_b128 v32, v[220:223] offset:8928
    s_waitcnt lgkmcnt(0)
    s_barrier
    v_lshrrev_b32 v32, 3, v1
    v_mul_u32_u24 v32, 272, v32
    v_and_b32 v33, 7, v1
    v_lshl_add_u32 v32, v33, 5, v32
    s_mul_i32 s60, s66, 4352
    s_add_u32 s60, s60, 16384
    v_add_u32 v32, s60, v32
    v_add_u32 v33, 67584, v32
    ds_read_b128 v[64:67], v32 offset:0
    ds_read_b128 v[68:71], v32 offset:16
    ds_read_b128 v[72:75], v32 offset:33792
    ds_read_b128 v[76:79], v32 offset:33808
    ds_read_b128 v[80:83], v33 offset:0
    ds_read_b128 v[84:87], v33 offset:16
    ds_read_b128 v[88:91], v33 offset:33792
    ds_read_b128 v[92:95], v33 offset:33808
    ds_read_b128 v[96:99], v32 offset:2176
    ds_read_b128 v[100:103], v32 offset:2192
    ds_read_b128 v[104:107], v32 offset:35968
    ds_read_b128 v[108:111], v32 offset:35984
    ds_read_b128 v[112:115], v33 offset:2176
    ds_read_b128 v[116:119], v33 offset:2192
    ds_read_b128 v[120:123], v33 offset:35968
    ds_read_b128 v[124:127], v33 offset:35984
    s_waitcnt lgkmcnt(8)
    v_add_f32 v64, v64, v72
    v_add_f32 v80, v80, v88
    v_add_f32 v65, v65, v73
    v_add_f32 v81, v81, v89
    v_add_f32 v66, v66, v74
    v_add_f32 v82, v82, v90
    v_add_f32 v67, v67, v75
    v_add_f32 v83, v83, v91
    v_add_f32 v68, v68, v76
    v_add_f32 v84, v84, v92
    v_add_f32 v69, v69, v77
    v_add_f32 v85, v85, v93
    v_add_f32 v70, v70, v78
    v_add_f32 v86, v86, v94
    v_add_f32 v71, v71, v79
    v_add_f32 v87, v87, v95
    v_add_f32 v64, v64, v80
    v_add_f32 v65, v65, v81
    v_add_f32 v66, v66, v82
    v_add_f32 v67, v67, v83
    v_add_f32 v68, v68, v84
    v_add_f32 v69, v69, v85
    v_add_f32 v70, v70, v86
    v_add_f32 v71, v71, v87
    s_waitcnt lgkmcnt(0)
    v_add_f32 v96, v96, v104
    v_add_f32 v112, v112, v120
    v_add_f32 v97, v97, v105
    v_add_f32 v113, v113, v121
    v_add_f32 v98, v98, v106
    v_add_f32 v114, v114, v122
    v_add_f32 v99, v99, v107
    v_add_f32 v115, v115, v123
    v_add_f32 v100, v100, v108
    v_add_f32 v116, v116, v124
    v_add_f32 v101, v101, v109
    v_add_f32 v117, v117, v125
    v_add_f32 v102, v102, v110
    v_add_f32 v118, v118, v126
    v_add_f32 v103, v103, v111
    v_add_f32 v119, v119, v127
    v_add_f32 v96, v96, v112
    v_add_f32 v97, v97, v113
    v_add_f32 v98, v98, v114
    v_add_f32 v99, v99, v115
    v_add_f32 v100, v100, v116
    v_add_f32 v101, v101, v117
    v_add_f32 v102, v102, v118
    v_add_f32 v103, v103, v119
    v_lshlrev_b32 v80, 16, v240
    v_and_b32 v81, 0xffff0000, v240
    v_lshlrev_b32 v82, 16, v241
    v_and_b32 v83, 0xffff0000, v241
    v_lshlrev_b32 v84, 16, v242
    v_and_b32 v85, 0xffff0000, v242
    v_lshlrev_b32 v86, 16, v243
    v_and_b32 v87, 0xffff0000, v243
    v_fmac_f32 v80, v64, v224
    v_fmac_f32 v81, v65, v225
    v_fmac_f32 v82, v66, v226
    v_fmac_f32 v83, v67, v227
    v_fmac_f32 v84, v68, v228
    v_fmac_f32 v85, v69, v229
    v_fmac_f32 v86, v70, v230
    v_fmac_f32 v87, v71, v231
    v_cvt_pk_bf16_f32 v72, v80, v81
    v_cvt_pk_bf16_f32 v73, v82, v83
    v_cvt_pk_bf16_f32 v74, v84, v85
    v_cvt_pk_bf16_f32 v75, v86, v87
    buffer_store_dwordx4 v[72:75], v40, s[48:51], s64 offen
    v_lshlrev_b32 v112, 16, v244
    v_and_b32 v113, 0xffff0000, v244
    v_lshlrev_b32 v114, 16, v245
    v_and_b32 v115, 0xffff0000, v245
    v_lshlrev_b32 v116, 16, v246
    v_and_b32 v117, 0xffff0000, v246
    v_lshlrev_b32 v118, 16, v247
    v_and_b32 v119, 0xffff0000, v247
    v_fmac_f32 v112, v96, v232
    v_fmac_f32 v113, v97, v233
    v_fmac_f32 v114, v98, v234
    v_fmac_f32 v115, v99, v235
    v_fmac_f32 v116, v100, v236
    v_fmac_f32 v117, v101, v237
    v_fmac_f32 v118, v102, v238
    v_fmac_f32 v119, v103, v239
    v_cvt_pk_bf16_f32 v104, v112, v113
    v_cvt_pk_bf16_f32 v105, v114, v115
    v_cvt_pk_bf16_f32 v106, v116, v117
    v_cvt_pk_bf16_f32 v107, v118, v119
    buffer_store_dwordx4 v[104:107], v40, s[48:51], s65 offen
L_EXIT:
    s_endpgm

.section .rodata,"a"
.p2align 6
.amdhsa_kernel recurrent_scan__grouped_kv_mqa__glu_gated_reglu__prompt_kernel
  .amdhsa_next_free_vgpr 248
  .amdhsa_next_free_sgpr 102
  .amdhsa_accum_offset 248
  .amdhsa_group_segment_fixed_size 0
  .amdhsa_kernarg_size 96
  .amdhsa_user_sgpr_count 2
  .amdhsa_user_sgpr_kernarg_segment_ptr 1
  .amdhsa_system_sgpr_workgroup_id_x 1
.end_amdhsa_kernel
```
